```python
import torch

def _softmax(x, axis=-1):
    return torch.softmax(x, dim=axis)
def _gelu(x):
    return torch.nn.functional.gelu(x, approximate="tanh")
def _silu(x):
    return torch.nn.functional.silu(x)
def _sigmoid(x):
    return torch.sigmoid(x)
def _layernorm(x, axis=-1, eps=1e-5):
    m = x.mean(dim=axis, keepdim=True)
    v = x.var(dim=axis, keepdim=True, unbiased=False)
    return (x - m) / torch.sqrt(v + eps)
def _scatter_add(tgt, idx, src, axis=0):
    return tgt.clone().index_add_(axis, idx, src)
def _segment_sum(src, seg, n):
    out = torch.zeros((n,) + src.shape[1:], dtype=src.dtype)
    return out.index_add_(0, seg, src)
def _pad(x, pw):
    flat = tuple(v for pair in reversed(pw) for v in pair)
    return torch.nn.functional.pad(x, flat)

kernel_name = 'concat_heads__mha_block__sliding_local_dilated__prompt'

def setup_inputs():

    _w = (lambda a: (lambda t: t.to(torch.bfloat16) if t.is_floating_point() else t)(torch.as_tensor(a)))
    def _A_setup():
        B, S, D, H = 1, 2048, 512, 32
        return {
            "x": _w((lambda *s: torch.randn(*s, dtype=torch.bfloat16) * 0.2)(B, S, D)),
            "wqkv": _w((lambda *s: torch.randn(*s, dtype=torch.bfloat16) * 0.4)(D, 3 * D)),
            "wo": _w((lambda *s: torch.randn(*s, dtype=torch.bfloat16) * 0.1)(D, D)),
        }
    _A_in = _A_setup()

    def _B_setup():
        B, S, D = 1, 2048, 512
        return {
            "x": _w((lambda *s: torch.randn(*s, dtype=torch.bfloat16) * 0.4)(B, S, D)),
            "wqkv": _w((lambda *s: torch.randn(*s, dtype=torch.bfloat16) * 0.4)(D, 3 * D)),
            "wo": _w((lambda *s: torch.randn(*s, dtype=torch.bfloat16) * 0.05)(D, D)),
        }
    _B_in = _B_setup()

    return {
        "A_x": _A_in["x"],
        "A_wqkv": _A_in["wqkv"],
        "A_wo": _A_in["wo"],
        "B_x": _B_in["x"],
        "B_wqkv": _B_in["wqkv"],
        "B_wo": _B_in["wo"],
    }

def reference(A_x, A_wqkv, A_wo, B_x, B_wqkv, B_wo):
    def _A_ref(x, wqkv, wo):
        B, S, D = x.shape
        H = 32
        Dh = D // H
        qkv = (lambda x, *d: x.permute(*d))((x @ wqkv).reshape(B, S, 3, H, Dh), 2, 0, 3, 1, 4)
        q, k, v = qkv[0], qkv[1], qkv[2]
        scores = torch.einsum("bhqd,bhkd->bhqk", q, k) * (Dh ** -0.5)
        p = _softmax(scores, axis=-1)
        o = torch.einsum("bhqk,bhkd->bhqd", p, v)
        return (lambda x, *d: x.permute(*d))(o, 0, 2, 1, 3).reshape(B, S, D) @ wo

    def _B_ref(x, wqkv, wo):
        B, S, D = x.shape
        H = 32; Dh = D // H
        W, dil = 8, 2
        qkv = (lambda x, *d: x.permute(*d))((x @ wqkv).reshape(B, S, 3, H, Dh), 2, 0, 3, 1, 4)
        q, k, v = qkv[0], qkv[1], qkv[2]
        scale = Dh ** -0.5
        pos = torch.arange(S)
        off = torch.arange(W) * dil
        idx = pos[:, None] - off[None, :]
        mask = idx >= 0
        idx_c = torch.where(mask, idx, 0).reshape(-1)
        kg = k[:, :, idx_c, :].reshape(B, H, S, W, Dh)
        vg = v[:, :, idx_c, :].reshape(B, H, S, W, Dh)
        logits = torch.einsum("bhsd,bhswd->bhsw", q, kg) * scale
        logits = torch.where(mask[None, None, :, :], logits, -1e9)
        attn = _softmax(logits, axis=-1)
        o = torch.einsum("bhsw,bhswd->bhsd", attn, vg)
        return (lambda x, *d: x.permute(*d))(o, 0, 2, 1, 3).reshape(B, S, D) @ wo

    a = _A_ref(A_x, A_wqkv, A_wo)
    b = _B_ref(B_x, B_wqkv, B_wo)
    return torch.concatenate([a, b], axis=-1)
```

```asm
; @launch grid=(256,1,1) block=(512,1,1) lds=163840
.amdgcn_target "amdgcn-amd-amdhsa--gfx950"
.text
.globl concat_heads__mha_block__sliding_local_dilated__prompt_kernel
.p2align 8
.type concat_heads__mha_block__sliding_local_dilated__prompt_kernel,@function
concat_heads__mha_block__sliding_local_dilated__prompt_kernel:
    s_cmp_ge_u32 s2, 256
    s_cbranch_scc1 concat_heads__mha_block__sliding_local_dilated__prompt_kernel_end
    s_load_dwordx4 s[4:7], s[0:1], 0
    s_load_dwordx2 s[32:33], s[0:1], 16
    s_load_dwordx2 s[8:9], s[0:1], 24
    s_load_dwordx4 s[44:47], s[0:1], 32
    s_load_dwordx2 s[36:37], s[0:1], 48
    s_load_dwordx4 s[48:51], s[0:1], 56
    v_lshrrev_b32 v4, 6, v0
    v_and_b32 v1, 63, v0
    s_and_b32 s42, s2, 7
    v_readfirstlane_b32 s14, v4
    s_lshr_b32 s43, s2, 3
    s_and_b32 s15, s42, 3
    s_lshl_b32 s15, s15, 3
    s_and_b32 s16, s43, 7
    s_add_u32 s15, s15, s16
    s_lshr_b32 s16, s42, 2
    s_lshl_b32 s16, s16, 2
    s_lshr_b32 s17, s43, 3
    s_add_u32 s16, s16, s17
    s_lshr_b32 s40, s43, 2
    s_lshl_b32 s17, s42, 2
    s_lshr_b32 s18, s43, 3
    s_add_u32 s17, s17, s18
    s_and_b32 s18, s43, 7
    s_lshl_b32 s19, s42, 2
    s_and_b32 s52, s43, 3
    s_add_u32 s19, s19, s52
    v_and_b32 v2, 15, v1
    v_lshrrev_b32 v3, 4, v1
    s_cmp_lt_u32 s14, 4
    s_cbranch_scc1 concat_heads__mha_block__sliding_local_dilated__prompt_kernel_gemm
    s_sub_u32 s52, s14, 4
    v_lshrrev_b32 v5, 3, v1
    v_and_b32 v6, 7, v1
    v_xor_b32 v7, v6, v3
    v_xor_b32 v8, 4, v7
    v_lshlrev_b32 v9, 10, v5
    v_lshl_add_u32 v10, v7, 4, v9
    v_lshl_add_u32 v11, v8, 4, v9
    s_lshl_b32 s53, s52, 1
    v_add_u32 v7, s53, v3
    v_and_b32 v7, 7, v7
    v_xor_b32 v7, v6, v7
    v_lshl_add_u32 v13, v7, 4, v9
    v_bfe_u32 v7, v1, 4, 1
    v_lshlrev_b32 v7, 1, v7
    v_xor_b32 v7, v6, v7
    v_xor_b32 v8, 4, v7
    v_mul_u32_u24 v9, 3072, v5
    v_lshl_add_u32 v12, v7, 4, v9
    v_lshl_add_u32 v14, v8, 4, v9
    s_lshl_b32 s53, s15, 16
    s_lshl_b32 s54, s52, 14
    s_add_u32 s53, s53, s54
    s_lshl_b32 s54, s52, 11
    s_lshl_b32 s55, s16, 7
    s_mul_i32 s56, s52, 49152
    s_add_u32 s55, s55, s56
    s_lshl_b32 s56, s52, 11
    s_add_u32 s56, s56, 81920
    s_lshl_b32 s57, s15, 6
    s_lshl_b32 s58, s52, 2
    s_add_u32 s57, s57, s58
    s_sub_u32 s57, s57, 16
    s_cmp_eq_u32 s15, 0
    s_cselect_b32 s57, 0, s57
    s_lshl_b32 s57, s57, 10
    s_lshl_b32 s58, s52, 9
    s_add_u32 s58, s58, 8192
    s_and_b32 s60, s15, 7
    s_waitcnt lgkmcnt(0)
    s_mov_b32 s20, s4
    s_mov_b32 s21, s5
    s_mov_b32 s22, 0x200000
    s_mov_b32 s23, 0x20000
    s_mov_b32 s24, s6
    s_mov_b32 s25, s7
    s_mov_b32 s26, 0x180000
    s_mov_b32 s27, 0x20000
    s_add_u32 s61, s60, 0
    s_and_b32 s61, s61, 7
    s_lshl_b32 s62, s61, 7
    s_add_u32 s63, s62, s53
    s_add_u32 m0, s54, 0
    s_add_u32 s59, s63, 0
    buffer_load_dwordx4 v10, s[20:23], s59 offen lds
    s_add_u32 m0, s54, 1024
    s_add_u32 s59, s63, 8192
    buffer_load_dwordx4 v11, s[20:23], s59 offen lds
    s_add_u32 s61, s60, 0
    s_and_b32 s61, s61, 7
    s_mul_i32 s61, s61, 196608
    s_add_u32 s61, s61, s55
    s_add_u32 m0, s56, 0
    s_add_u32 s59, s61, 0
    buffer_load_dwordx4 v12, s[24:27], s59 offen lds
    s_add_u32 m0, s56, 1024
    s_add_u32 s59, s61, 24576
    buffer_load_dwordx4 v14, s[24:27], s59 offen lds
    s_add_u32 m0, s56, 8192
    s_add_u32 s59, s61, 1024
    buffer_load_dwordx4 v12, s[24:27], s59 offen lds
    s_add_u32 m0, s56, 9216
    s_add_u32 s59, s61, 25600
    buffer_load_dwordx4 v14, s[24:27], s59 offen lds
    s_add_u32 m0, s56, 16384
    s_add_u32 s59, s61, 2048
    buffer_load_dwordx4 v12, s[24:27], s59 offen lds
    s_add_u32 m0, s56, 17408
    s_add_u32 s59, s61, 26624
    buffer_load_dwordx4 v14, s[24:27], s59 offen lds
    s_mov_b32 s10, s44
    s_mov_b32 s11, s45
    s_mov_b32 s34, s46
    s_mov_b32 s35, s47
    s_mov_b32 s38, s48
    s_mov_b32 s39, s49
    s_mov_b32 s28, s50
    s_mov_b32 s29, s51
    s_mov_b32 s30, 0x1000000
    s_mov_b32 s31, 0x20000
    s_mov_b32 s4, s8
    s_mov_b32 s5, s9
    s_mov_b32 s6, 0x200000
    s_mov_b32 s7, 0x20000
    s_mov_b32 s8, s10
    s_mov_b32 s9, s11
    s_mov_b32 s10, 0x180000
    s_mov_b32 s11, 0x20000
    s_add_u32 s61, s60, 1
    s_and_b32 s61, s61, 7
    s_lshl_b32 s62, s61, 7
    s_add_u32 s63, s62, s53
    s_add_u32 m0, s54, 10240
    s_add_u32 s59, s63, 0
    buffer_load_dwordx4 v10, s[20:23], s59 offen lds
    s_add_u32 m0, s54, 11264
    s_add_u32 s59, s63, 8192
    buffer_load_dwordx4 v11, s[20:23], s59 offen lds
    s_add_u32 s61, s60, 1
    s_and_b32 s61, s61, 7
    s_mul_i32 s61, s61, 196608
    s_add_u32 s61, s61, s55
    s_add_u32 m0, s56, 24576
    s_add_u32 s59, s61, 0
    buffer_load_dwordx4 v12, s[24:27], s59 offen lds
    s_add_u32 m0, s56, 25600
    s_add_u32 s59, s61, 24576
    buffer_load_dwordx4 v14, s[24:27], s59 offen lds
    s_add_u32 m0, s56, 32768
    s_add_u32 s59, s61, 1024
    buffer_load_dwordx4 v12, s[24:27], s59 offen lds
    s_add_u32 m0, s56, 33792
    s_add_u32 s59, s61, 25600
    buffer_load_dwordx4 v14, s[24:27], s59 offen lds
    s_add_u32 m0, s56, 40960
    s_add_u32 s59, s61, 2048
    buffer_load_dwordx4 v12, s[24:27], s59 offen lds
    s_add_u32 m0, s56, 41984
    s_add_u32 s59, s61, 26624
    buffer_load_dwordx4 v14, s[24:27], s59 offen lds
    s_add_u32 s61, s60, 2
    s_and_b32 s61, s61, 7
    s_lshl_b32 s62, s61, 7
    s_add_u32 s63, s62, s53
    s_add_u32 m0, s54, 20480
    s_add_u32 s59, s63, 0
    buffer_load_dwordx4 v10, s[20:23], s59 offen lds
    s_add_u32 m0, s54, 21504
    s_add_u32 s59, s63, 8192
    buffer_load_dwordx4 v11, s[20:23], s59 offen lds
    s_waitcnt vmcnt(10)
    s_barrier
    s_add_u32 s61, s60, 2
    s_and_b32 s61, s61, 7
    s_mul_i32 s61, s61, 196608
    s_add_u32 s61, s61, s55
    s_add_u32 m0, s56, 49152
    s_add_u32 s59, s61, 0
    buffer_load_dwordx4 v12, s[24:27], s59 offen lds
    s_add_u32 m0, s56, 50176
    s_add_u32 s59, s61, 24576
    buffer_load_dwordx4 v14, s[24:27], s59 offen lds
    s_add_u32 m0, s56, 57344
    s_add_u32 s59, s61, 1024
    buffer_load_dwordx4 v12, s[24:27], s59 offen lds
    s_add_u32 m0, s56, 58368
    s_add_u32 s59, s61, 25600
    buffer_load_dwordx4 v14, s[24:27], s59 offen lds
    s_add_u32 m0, s56, 65536
    s_add_u32 s59, s61, 2048
    buffer_load_dwordx4 v12, s[24:27], s59 offen lds
    s_add_u32 m0, s56, 66560
    s_add_u32 s59, s61, 26624
    buffer_load_dwordx4 v14, s[24:27], s59 offen lds
    s_add_u32 s61, s60, 3
    s_and_b32 s61, s61, 7
    s_lshl_b32 s62, s61, 7
    s_add_u32 s63, s62, s53
    s_add_u32 m0, s54, 30720
    s_add_u32 s59, s63, 0
    buffer_load_dwordx4 v10, s[20:23], s59 offen lds
    s_add_u32 m0, s54, 31744
    s_add_u32 s59, s63, 8192
    buffer_load_dwordx4 v11, s[20:23], s59 offen lds
    s_add_u32 s61, s60, 4
    s_and_b32 s61, s61, 7
    s_lshl_b32 s62, s61, 7
    s_add_u32 s63, s62, s53
    s_add_u32 m0, s54, 40960
    s_add_u32 s59, s63, 0
    buffer_load_dwordx4 v10, s[20:23], s59 offen lds
    s_add_u32 m0, s54, 41984
    s_add_u32 s59, s63, 8192
    buffer_load_dwordx4 v11, s[20:23], s59 offen lds
    s_waitcnt vmcnt(12)
    s_barrier
    s_add_u32 s61, s60, 3
    s_and_b32 s61, s61, 7
    s_mul_i32 s61, s61, 196608
    s_add_u32 s61, s61, s55
    s_add_u32 m0, s56, 0
    s_add_u32 s59, s61, 0
    buffer_load_dwordx4 v12, s[24:27], s59 offen lds
    s_add_u32 m0, s56, 1024
    s_add_u32 s59, s61, 24576
    buffer_load_dwordx4 v14, s[24:27], s59 offen lds
    s_add_u32 m0, s56, 8192
    s_add_u32 s59, s61, 1024
    buffer_load_dwordx4 v12, s[24:27], s59 offen lds
    s_add_u32 m0, s56, 9216
    s_add_u32 s59, s61, 25600
    buffer_load_dwordx4 v14, s[24:27], s59 offen lds
    s_add_u32 m0, s56, 16384
    s_add_u32 s59, s61, 2048
    buffer_load_dwordx4 v12, s[24:27], s59 offen lds
    s_add_u32 m0, s56, 17408
    s_add_u32 s59, s61, 26624
    buffer_load_dwordx4 v14, s[24:27], s59 offen lds
    s_add_u32 s61, s60, 5
    s_and_b32 s61, s61, 7
    s_lshl_b32 s62, s61, 7
    s_add_u32 s63, s62, s53
    s_add_u32 m0, s54, 51200
    s_add_u32 s59, s63, 0
    buffer_load_dwordx4 v10, s[20:23], s59 offen lds
    s_add_u32 m0, s54, 52224
    s_add_u32 s59, s63, 8192
    buffer_load_dwordx4 v11, s[20:23], s59 offen lds
    s_add_u32 s61, s60, 6
    s_and_b32 s61, s61, 7
    s_lshl_b32 s62, s61, 7
    s_add_u32 s63, s62, s53
    s_add_u32 m0, s54, 61440
    s_add_u32 s59, s63, 0
    buffer_load_dwordx4 v10, s[20:23], s59 offen lds
    s_add_u32 m0, s54, 62464
    s_add_u32 s59, s63, 8192
    buffer_load_dwordx4 v11, s[20:23], s59 offen lds
    s_waitcnt vmcnt(14)
    s_barrier
    s_add_u32 s61, s60, 4
    s_and_b32 s61, s61, 7
    s_mul_i32 s61, s61, 196608
    s_add_u32 s61, s61, s55
    s_add_u32 m0, s56, 24576
    s_add_u32 s59, s61, 0
    buffer_load_dwordx4 v12, s[24:27], s59 offen lds
    s_add_u32 m0, s56, 25600
    s_add_u32 s59, s61, 24576
    buffer_load_dwordx4 v14, s[24:27], s59 offen lds
    s_add_u32 m0, s56, 32768
    s_add_u32 s59, s61, 1024
    buffer_load_dwordx4 v12, s[24:27], s59 offen lds
    s_add_u32 m0, s56, 33792
    s_add_u32 s59, s61, 25600
    buffer_load_dwordx4 v14, s[24:27], s59 offen lds
    s_add_u32 m0, s56, 40960
    s_add_u32 s59, s61, 2048
    buffer_load_dwordx4 v12, s[24:27], s59 offen lds
    s_add_u32 m0, s56, 41984
    s_add_u32 s59, s61, 26624
    buffer_load_dwordx4 v14, s[24:27], s59 offen lds
    s_add_u32 s61, s60, 7
    s_and_b32 s61, s61, 7
    s_lshl_b32 s62, s61, 7
    s_add_u32 s63, s62, s53
    s_add_u32 m0, s54, 71680
    s_add_u32 s59, s63, 0
    buffer_load_dwordx4 v10, s[20:23], s59 offen lds
    s_add_u32 m0, s54, 72704
    s_add_u32 s59, s63, 8192
    buffer_load_dwordx4 v11, s[20:23], s59 offen lds
    s_add_u32 s61, s60, 0
    s_and_b32 s61, s61, 7
    s_lshl_b32 s62, s61, 7
    s_add_u32 s63, s62, s53
    s_add_u32 m0, s54, 0
    s_add_u32 s59, s63, 0
    buffer_load_dwordx4 v10, s[4:7], s59 offen lds
    s_add_u32 m0, s54, 1024
    s_add_u32 s59, s63, 8192
    buffer_load_dwordx4 v11, s[4:7], s59 offen lds
    s_add_u32 m0, s58, 0
    s_add_u32 s59, s57, s62
    s_mov_b32 exec_hi, 0
    buffer_load_dwordx4 v13, s[4:7], s59 offen lds
    s_mov_b64 exec, -1
    s_waitcnt vmcnt(15)
    s_barrier
    s_add_u32 s61, s60, 5
    s_and_b32 s61, s61, 7
    s_mul_i32 s61, s61, 196608
    s_add_u32 s61, s61, s55
    s_add_u32 m0, s56, 49152
    s_add_u32 s59, s61, 0
    buffer_load_dwordx4 v12, s[24:27], s59 offen lds
    s_add_u32 m0, s56, 50176
    s_add_u32 s59, s61, 24576
    buffer_load_dwordx4 v14, s[24:27], s59 offen lds
    s_add_u32 m0, s56, 57344
    s_add_u32 s59, s61, 1024
    buffer_load_dwordx4 v12, s[24:27], s59 offen lds
    s_add_u32 m0, s56, 58368
    s_add_u32 s59, s61, 25600
    buffer_load_dwordx4 v14, s[24:27], s59 offen lds
    s_add_u32 m0, s56, 65536
    s_add_u32 s59, s61, 2048
    buffer_load_dwordx4 v12, s[24:27], s59 offen lds
    s_add_u32 m0, s56, 66560
    s_add_u32 s59, s61, 26624
    buffer_load_dwordx4 v14, s[24:27], s59 offen lds
    s_add_u32 s61, s60, 1
    s_and_b32 s61, s61, 7
    s_lshl_b32 s62, s61, 7
    s_add_u32 s63, s62, s53
    s_add_u32 m0, s54, 10240
    s_add_u32 s59, s63, 0
    buffer_load_dwordx4 v10, s[4:7], s59 offen lds
    s_add_u32 m0, s54, 11264
    s_add_u32 s59, s63, 8192
    buffer_load_dwordx4 v11, s[4:7], s59 offen lds
    s_add_u32 m0, s58, 10240
    s_add_u32 s59, s57, s62
    s_mov_b32 exec_hi, 0
    buffer_load_dwordx4 v13, s[4:7], s59 offen lds
    s_mov_b64 exec, -1
    s_add_u32 s61, s60, 2
    s_and_b32 s61, s61, 7
    s_lshl_b32 s62, s61, 7
    s_add_u32 s63, s62, s53
    s_add_u32 m0, s54, 20480
    s_add_u32 s59, s63, 0
    buffer_load_dwordx4 v10, s[4:7], s59 offen lds
    s_add_u32 m0, s54, 21504
    s_add_u32 s59, s63, 8192
    buffer_load_dwordx4 v11, s[4:7], s59 offen lds
    s_add_u32 m0, s58, 20480
    s_add_u32 s59, s57, s62
    s_mov_b32 exec_hi, 0
    buffer_load_dwordx4 v13, s[4:7], s59 offen lds
    s_mov_b64 exec, -1
    s_waitcnt vmcnt(17)
    s_barrier
    s_add_u32 s61, s60, 6
    s_and_b32 s61, s61, 7
    s_mul_i32 s61, s61, 196608
    s_add_u32 s61, s61, s55
    s_add_u32 m0, s56, 0
    s_add_u32 s59, s61, 0
    buffer_load_dwordx4 v12, s[24:27], s59 offen lds
    s_add_u32 m0, s56, 1024
    s_add_u32 s59, s61, 24576
    buffer_load_dwordx4 v14, s[24:27], s59 offen lds
    s_add_u32 m0, s56, 8192
    s_add_u32 s59, s61, 1024
    buffer_load_dwordx4 v12, s[24:27], s59 offen lds
    s_add_u32 m0, s56, 9216
    s_add_u32 s59, s61, 25600
    buffer_load_dwordx4 v14, s[24:27], s59 offen lds
    s_add_u32 m0, s56, 16384
    s_add_u32 s59, s61, 2048
    buffer_load_dwordx4 v12, s[24:27], s59 offen lds
    s_add_u32 m0, s56, 17408
    s_add_u32 s59, s61, 26624
    buffer_load_dwordx4 v14, s[24:27], s59 offen lds
    s_add_u32 s61, s60, 3
    s_and_b32 s61, s61, 7
    s_lshl_b32 s62, s61, 7
    s_add_u32 s63, s62, s53
    s_add_u32 m0, s54, 30720
    s_add_u32 s59, s63, 0
    buffer_load_dwordx4 v10, s[4:7], s59 offen lds
    s_add_u32 m0, s54, 31744
    s_add_u32 s59, s63, 8192
    buffer_load_dwordx4 v11, s[4:7], s59 offen lds
    s_add_u32 m0, s58, 30720
    s_add_u32 s59, s57, s62
    s_mov_b32 exec_hi, 0
    buffer_load_dwordx4 v13, s[4:7], s59 offen lds
    s_mov_b64 exec, -1
    s_waitcnt vmcnt(15)
    s_barrier
    s_add_u32 s61, s60, 7
    s_and_b32 s61, s61, 7
    s_mul_i32 s61, s61, 196608
    s_add_u32 s61, s61, s55
    s_add_u32 m0, s56, 24576
    s_add_u32 s59, s61, 0
    buffer_load_dwordx4 v12, s[24:27], s59 offen lds
    s_add_u32 m0, s56, 25600
    s_add_u32 s59, s61, 24576
    buffer_load_dwordx4 v14, s[24:27], s59 offen lds
    s_add_u32 m0, s56, 32768
    s_add_u32 s59, s61, 1024
    buffer_load_dwordx4 v12, s[24:27], s59 offen lds
    s_add_u32 m0, s56, 33792
    s_add_u32 s59, s61, 25600
    buffer_load_dwordx4 v14, s[24:27], s59 offen lds
    s_add_u32 m0, s56, 40960
    s_add_u32 s59, s61, 2048
    buffer_load_dwordx4 v12, s[24:27], s59 offen lds
    s_add_u32 m0, s56, 41984
    s_add_u32 s59, s61, 26624
    buffer_load_dwordx4 v14, s[24:27], s59 offen lds
    s_add_u32 s61, s60, 4
    s_and_b32 s61, s61, 7
    s_lshl_b32 s62, s61, 7
    s_add_u32 s63, s62, s53
    s_add_u32 m0, s54, 40960
    s_add_u32 s59, s63, 0
    buffer_load_dwordx4 v10, s[4:7], s59 offen lds
    s_add_u32 m0, s54, 41984
    s_add_u32 s59, s63, 8192
    buffer_load_dwordx4 v11, s[4:7], s59 offen lds
    s_add_u32 m0, s58, 40960
    s_add_u32 s59, s57, s62
    s_mov_b32 exec_hi, 0
    buffer_load_dwordx4 v13, s[4:7], s59 offen lds
    s_mov_b64 exec, -1
    s_waitcnt vmcnt(12)
    s_barrier
    s_add_u32 s61, s60, 0
    s_and_b32 s61, s61, 7
    s_mul_i32 s61, s61, 196608
    s_add_u32 s61, s61, s55
    s_add_u32 m0, s56, 49152
    s_add_u32 s59, s61, 0
    buffer_load_dwordx4 v12, s[8:11], s59 offen lds
    s_add_u32 m0, s56, 50176
    s_add_u32 s59, s61, 24576
    buffer_load_dwordx4 v14, s[8:11], s59 offen lds
    s_add_u32 m0, s56, 57344
    s_add_u32 s59, s61, 1024
    buffer_load_dwordx4 v12, s[8:11], s59 offen lds
    s_add_u32 m0, s56, 58368
    s_add_u32 s59, s61, 25600
    buffer_load_dwordx4 v14, s[8:11], s59 offen lds
    s_add_u32 m0, s56, 65536
    s_add_u32 s59, s61, 2048
    buffer_load_dwordx4 v12, s[8:11], s59 offen lds
    s_add_u32 m0, s56, 66560
    s_add_u32 s59, s61, 26624
    buffer_load_dwordx4 v14, s[8:11], s59 offen lds
    s_add_u32 s61, s60, 5
    s_and_b32 s61, s61, 7
    s_lshl_b32 s62, s61, 7
    s_add_u32 s63, s62, s53
    s_add_u32 m0, s54, 51200
    s_add_u32 s59, s63, 0
    buffer_load_dwordx4 v10, s[4:7], s59 offen lds
    s_add_u32 m0, s54, 52224
    s_add_u32 s59, s63, 8192
    buffer_load_dwordx4 v11, s[4:7], s59 offen lds
    s_add_u32 m0, s58, 51200
    s_add_u32 s59, s57, s62
    s_mov_b32 exec_hi, 0
    buffer_load_dwordx4 v13, s[4:7], s59 offen lds
    s_mov_b64 exec, -1
    s_waitcnt vmcnt(12)
    s_barrier
    s_add_u32 s61, s60, 1
    s_and_b32 s61, s61, 7
    s_mul_i32 s61, s61, 196608
    s_add_u32 s61, s61, s55
    s_add_u32 m0, s56, 0
    s_add_u32 s59, s61, 0
    buffer_load_dwordx4 v12, s[8:11], s59 offen lds
    s_add_u32 m0, s56, 1024
    s_add_u32 s59, s61, 24576
    buffer_load_dwordx4 v14, s[8:11], s59 offen lds
    s_add_u32 m0, s56, 8192
    s_add_u32 s59, s61, 1024
    buffer_load_dwordx4 v12, s[8:11], s59 offen lds
    s_add_u32 m0, s56, 9216
    s_add_u32 s59, s61, 25600
    buffer_load_dwordx4 v14, s[8:11], s59 offen lds
    s_add_u32 m0, s56, 16384
    s_add_u32 s59, s61, 2048
    buffer_load_dwordx4 v12, s[8:11], s59 offen lds
    s_add_u32 m0, s56, 17408
    s_add_u32 s59, s61, 26624
    buffer_load_dwordx4 v14, s[8:11], s59 offen lds
    s_add_u32 s61, s60, 6
    s_and_b32 s61, s61, 7
    s_lshl_b32 s62, s61, 7
    s_add_u32 s63, s62, s53
    s_add_u32 m0, s54, 61440
    s_add_u32 s59, s63, 0
    buffer_load_dwordx4 v10, s[4:7], s59 offen lds
    s_add_u32 m0, s54, 62464
    s_add_u32 s59, s63, 8192
    buffer_load_dwordx4 v11, s[4:7], s59 offen lds
    s_add_u32 m0, s58, 61440
    s_add_u32 s59, s57, s62
    s_mov_b32 exec_hi, 0
    buffer_load_dwordx4 v13, s[4:7], s59 offen lds
    s_mov_b64 exec, -1
    s_waitcnt vmcnt(12)
    s_barrier
    s_add_u32 s61, s60, 2
    s_and_b32 s61, s61, 7
    s_mul_i32 s61, s61, 196608
    s_add_u32 s61, s61, s55
    s_add_u32 m0, s56, 24576
    s_add_u32 s59, s61, 0
    buffer_load_dwordx4 v12, s[8:11], s59 offen lds
    s_add_u32 m0, s56, 25600
    s_add_u32 s59, s61, 24576
    buffer_load_dwordx4 v14, s[8:11], s59 offen lds
    s_add_u32 m0, s56, 32768
    s_add_u32 s59, s61, 1024
    buffer_load_dwordx4 v12, s[8:11], s59 offen lds
    s_add_u32 m0, s56, 33792
    s_add_u32 s59, s61, 25600
    buffer_load_dwordx4 v14, s[8:11], s59 offen lds
    s_add_u32 m0, s56, 40960
    s_add_u32 s59, s61, 2048
    buffer_load_dwordx4 v12, s[8:11], s59 offen lds
    s_add_u32 m0, s56, 41984
    s_add_u32 s59, s61, 26624
    buffer_load_dwordx4 v14, s[8:11], s59 offen lds
    s_add_u32 s61, s60, 7
    s_and_b32 s61, s61, 7
    s_lshl_b32 s62, s61, 7
    s_add_u32 s63, s62, s53
    s_add_u32 m0, s54, 71680
    s_add_u32 s59, s63, 0
    buffer_load_dwordx4 v10, s[4:7], s59 offen lds
    s_add_u32 m0, s54, 72704
    s_add_u32 s59, s63, 8192
    buffer_load_dwordx4 v11, s[4:7], s59 offen lds
    s_add_u32 m0, s58, 71680
    s_add_u32 s59, s57, s62
    s_mov_b32 exec_hi, 0
    buffer_load_dwordx4 v13, s[4:7], s59 offen lds
    s_mov_b64 exec, -1
    s_waitcnt vmcnt(12)
    s_barrier
    s_add_u32 s61, s60, 3
    s_and_b32 s61, s61, 7
    s_mul_i32 s61, s61, 196608
    s_add_u32 s61, s61, s55
    s_add_u32 m0, s56, 49152
    s_add_u32 s59, s61, 0
    buffer_load_dwordx4 v12, s[8:11], s59 offen lds
    s_add_u32 m0, s56, 50176
    s_add_u32 s59, s61, 24576
    buffer_load_dwordx4 v14, s[8:11], s59 offen lds
    s_add_u32 m0, s56, 57344
    s_add_u32 s59, s61, 1024
    buffer_load_dwordx4 v12, s[8:11], s59 offen lds
    s_add_u32 m0, s56, 58368
    s_add_u32 s59, s61, 25600
    buffer_load_dwordx4 v14, s[8:11], s59 offen lds
    s_add_u32 m0, s56, 65536
    s_add_u32 s59, s61, 2048
    buffer_load_dwordx4 v12, s[8:11], s59 offen lds
    s_add_u32 m0, s56, 66560
    s_add_u32 s59, s61, 26624
    buffer_load_dwordx4 v14, s[8:11], s59 offen lds
    s_waitcnt vmcnt(9)
    s_barrier
    s_add_u32 s61, s60, 4
    s_and_b32 s61, s61, 7
    s_mul_i32 s61, s61, 196608
    s_add_u32 s61, s61, s55
    s_add_u32 m0, s56, 0
    s_add_u32 s59, s61, 0
    buffer_load_dwordx4 v12, s[8:11], s59 offen lds
    s_add_u32 m0, s56, 1024
    s_add_u32 s59, s61, 24576
    buffer_load_dwordx4 v14, s[8:11], s59 offen lds
    s_add_u32 m0, s56, 8192
    s_add_u32 s59, s61, 1024
    buffer_load_dwordx4 v12, s[8:11], s59 offen lds
    s_add_u32 m0, s56, 9216
    s_add_u32 s59, s61, 25600
    buffer_load_dwordx4 v14, s[8:11], s59 offen lds
    s_add_u32 m0, s56, 16384
    s_add_u32 s59, s61, 2048
    buffer_load_dwordx4 v12, s[8:11], s59 offen lds
    s_add_u32 m0, s56, 17408
    s_add_u32 s59, s61, 26624
    buffer_load_dwordx4 v14, s[8:11], s59 offen lds
    s_waitcnt vmcnt(6)
    s_barrier
    s_add_u32 s61, s60, 5
    s_and_b32 s61, s61, 7
    s_mul_i32 s61, s61, 196608
    s_add_u32 s61, s61, s55
    s_add_u32 m0, s56, 24576
    s_add_u32 s59, s61, 0
    buffer_load_dwordx4 v12, s[8:11], s59 offen lds
    s_add_u32 m0, s56, 25600
    s_add_u32 s59, s61, 24576
    buffer_load_dwordx4 v14, s[8:11], s59 offen lds
    s_add_u32 m0, s56, 32768
    s_add_u32 s59, s61, 1024
    buffer_load_dwordx4 v12, s[8:11], s59 offen lds
    s_add_u32 m0, s56, 33792
    s_add_u32 s59, s61, 25600
    buffer_load_dwordx4 v14, s[8:11], s59 offen lds
    s_add_u32 m0, s56, 40960
    s_add_u32 s59, s61, 2048
    buffer_load_dwordx4 v12, s[8:11], s59 offen lds
    s_add_u32 m0, s56, 41984
    s_add_u32 s59, s61, 26624
    buffer_load_dwordx4 v14, s[8:11], s59 offen lds
    s_waitcnt vmcnt(6)
    s_barrier
    s_add_u32 s61, s60, 6
    s_and_b32 s61, s61, 7
    s_mul_i32 s61, s61, 196608
    s_add_u32 s61, s61, s55
    s_add_u32 m0, s56, 49152
    s_add_u32 s59, s61, 0
    buffer_load_dwordx4 v12, s[8:11], s59 offen lds
    s_add_u32 m0, s56, 50176
    s_add_u32 s59, s61, 24576
    buffer_load_dwordx4 v14, s[8:11], s59 offen lds
    s_add_u32 m0, s56, 57344
    s_add_u32 s59, s61, 1024
    buffer_load_dwordx4 v12, s[8:11], s59 offen lds
    s_add_u32 m0, s56, 58368
    s_add_u32 s59, s61, 25600
    buffer_load_dwordx4 v14, s[8:11], s59 offen lds
    s_add_u32 m0, s56, 65536
    s_add_u32 s59, s61, 2048
    buffer_load_dwordx4 v12, s[8:11], s59 offen lds
    s_add_u32 m0, s56, 66560
    s_add_u32 s59, s61, 26624
    buffer_load_dwordx4 v14, s[8:11], s59 offen lds
    s_waitcnt vmcnt(6)
    s_barrier
    s_add_u32 s61, s60, 7
    s_and_b32 s61, s61, 7
    s_mul_i32 s61, s61, 196608
    s_add_u32 s61, s61, s55
    s_add_u32 m0, s56, 0
    s_add_u32 s59, s61, 0
    buffer_load_dwordx4 v12, s[8:11], s59 offen lds
    s_add_u32 m0, s56, 1024
    s_add_u32 s59, s61, 24576
    buffer_load_dwordx4 v14, s[8:11], s59 offen lds
    s_add_u32 m0, s56, 8192
    s_add_u32 s59, s61, 1024
    buffer_load_dwordx4 v12, s[8:11], s59 offen lds
    s_add_u32 m0, s56, 9216
    s_add_u32 s59, s61, 25600
    buffer_load_dwordx4 v14, s[8:11], s59 offen lds
    s_add_u32 m0, s56, 16384
    s_add_u32 s59, s61, 2048
    buffer_load_dwordx4 v12, s[8:11], s59 offen lds
    s_add_u32 m0, s56, 17408
    s_add_u32 s59, s61, 26624
    buffer_load_dwordx4 v14, s[8:11], s59 offen lds
    s_waitcnt vmcnt(6)
    s_barrier
    s_waitcnt vmcnt(0)
    s_barrier
    v_mov_b32 v5, 163776
    ds_read_b32 v6, v5
    s_waitcnt lgkmcnt(0)
    v_readfirstlane_b32 s41, v6
    v_and_b32 v2, 31, v1
    v_lshrrev_b32 v3, 5, v1
    v_lshlrev_b32 v4, 4, v1
    v_lshrrev_b32 v5, 2, v2
    v_mov_b32 v6, 0x69
    v_lshrrev_b32 v6, v5, v6
    v_and_b32 v6, 1, v6
    v_cmp_eq_u32 s[42:43], 1, v6
    v_lshlrev_b32 v6, 1, v5
    v_mov_b32 v7, 0x1c80
    v_lshrrev_b32 v6, v6, v7
    v_and_b32 v6, 3, v6
    v_and_b32 v7, 3, v2
    v_lshl_add_u32 v6, v6, 2, v7
    v_lshlrev_b32 v6, 4, v6
    v_lshl_add_u32 v5, v3, 8, v6
    v_cmp_eq_u32 s[44:45], 8, v2
    s_mov_b32 s46, 0
    s_mov_b32 s47, -1
    s_barrier
    s_lshl_b32 s53, s17, 8
    s_add_u32 s53, s53, 10485760
    s_mov_b32 exec_hi, 0
    v_lshlrev_b32 v9, 2, v1
    s_mov_b32 s49, 0
    buffer_load_dword v200, v9, s[28:31], s53 offen sc1
    s_sleep 2
    buffer_load_dword v201, v9, s[28:31], s53 offen sc1
    s_sleep 2
    buffer_load_dword v202, v9, s[28:31], s53 offen sc1
    s_sleep 2
    buffer_load_dword v203, v9, s[28:31], s53 offen sc1
concat_heads__mha_block__sliding_local_dilated__prompt_kernel_kvpoll:
    s_waitcnt vmcnt(3)
    v_cmp_eq_u32 vcc, s41, v200
    s_nop 3
    s_cmp_eq_u64 vcc, exec
    s_cbranch_scc1 concat_heads__mha_block__sliding_local_dilated__prompt_kernel_kvpoll_got
    buffer_load_dword v200, v9, s[28:31], s53 offen sc1
    s_waitcnt vmcnt(3)
    v_cmp_eq_u32 vcc, s41, v201
    s_nop 3
    s_cmp_eq_u64 vcc, exec
    s_cbranch_scc1 concat_heads__mha_block__sliding_local_dilated__prompt_kernel_kvpoll_got
    buffer_load_dword v201, v9, s[28:31], s53 offen sc1
    s_waitcnt vmcnt(3)
    v_cmp_eq_u32 vcc, s41, v202
    s_nop 3
    s_cmp_eq_u64 vcc, exec
    s_cbranch_scc1 concat_heads__mha_block__sliding_local_dilated__prompt_kernel_kvpoll_got
    buffer_load_dword v202, v9, s[28:31], s53 offen sc1
    s_waitcnt vmcnt(3)
    v_cmp_eq_u32 vcc, s41, v203
    s_nop 3
    s_cmp_eq_u64 vcc, exec
    s_cbranch_scc1 concat_heads__mha_block__sliding_local_dilated__prompt_kernel_kvpoll_got
    buffer_load_dword v203, v9, s[28:31], s53 offen sc1
    s_add_u32 s49, s49, 1
    s_cmp_lt_u32 s49, 200000
    s_cbranch_scc1 concat_heads__mha_block__sliding_local_dilated__prompt_kernel_kvpoll
concat_heads__mha_block__sliding_local_dilated__prompt_kernel_kvpoll_got:
    s_mov_b64 exec, -1
    s_and_b32 s52, s14, 3
    s_lshr_b32 s53, s14, 2
    s_lshl_b32 s54, s18, 3
    s_lshl_b32 s55, s52, 1
    s_add_u32 s54, s54, s55
    s_lshl_b32 s55, s17, 16
    s_lshl_b32 s56, s54, 10
    s_add_u32 s55, s55, s56
    buffer_load_dwordx4 v[80:83], v4, s[28:31], s55 offen sc1
    buffer_load_dwordx4 v[76:79], v4, s[28:31], s55 offen offset:1024 sc1
    s_sub_u32 s56, s14, 4
    s_lshl_b32 s57, s17, 17
    s_lshl_b32 s58, s56, 11
    s_add_u32 s57, s57, s58
    s_add_u32 s57, s57, 2097152
    s_mul_i32 s58, s56, 2080
    s_add_u32 m0, s58, 0
    s_add_u32 s59, s57, 0
    buffer_load_dwordx4 v4, s[28:31], s59 offen sc1 lds
    buffer_load_dwordx4 v4, s[28:31], s59 offen offset:1024 sc1 lds
    s_add_u32 m0, s58, 66560
    s_add_u32 s59, s57, 65536
    buffer_load_dwordx4 v4, s[28:31], s59 offen sc1 lds
    buffer_load_dwordx4 v4, s[28:31], s59 offen offset:1024 sc1 lds
    s_add_u32 m0, s58, 8320
    s_add_u32 s59, s57, 8192
    buffer_load_dwordx4 v4, s[28:31], s59 offen sc1 lds
    buffer_load_dwordx4 v4, s[28:31], s59 offen offset:1024 sc1 lds
    s_add_u32 m0, s58, 74880
    s_add_u32 s59, s57, 73728
    buffer_load_dwordx4 v4, s[28:31], s59 offen sc1 lds
    buffer_load_dwordx4 v4, s[28:31], s59 offen offset:1024 sc1 lds
    s_add_u32 m0, s58, 16640
    s_add_u32 s59, s57, 16384
    buffer_load_dwordx4 v4, s[28:31], s59 offen sc1 lds
    buffer_load_dwordx4 v4, s[28:31], s59 offen offset:1024 sc1 lds
    s_add_u32 m0, s58, 83200
    s_add_u32 s59, s57, 81920
    buffer_load_dwordx4 v4, s[28:31], s59 offen sc1 lds
    buffer_load_dwordx4 v4, s[28:31], s59 offen offset:1024 sc1 lds
    s_cmp_lg_u32 s14, 4
    s_cbranch_scc1 concat_heads__mha_block__sliding_local_dilated__prompt_kernel_noones
    v_mov_b32 v8, 0x3f803f80
    v_mov_b32 v9, 0x3f803f80
    v_mov_b32 v10, 0x3f803f80
    v_mov_b32 v11, 0x3f803f80
    v_mov_b32 v12, 0
    v_mov_b32 v13, 0
    v_mov_b32 v14, 0
    v_mov_b32 v15, 0
    v_mul_u32_u24 v7, 2080, v1
    ds_write_b128 v7, v[8:11] offset:2048
    ds_write_b128 v7, v[12:15] offset:2064
    v_mov_b32 v7, 163760
    ds_write_b128 v7, v[12:15]
concat_heads__mha_block__sliding_local_dilated__prompt_kernel_noones:
    s_branch concat_heads__mha_block__sliding_local_dilated__prompt_kernel_p3
concat_heads__mha_block__sliding_local_dilated__prompt_kernel_kvrest:
    s_sub_u32 s56, s14, 4
    s_lshl_b32 s57, s17, 17
    s_lshl_b32 s58, s56, 11
    s_add_u32 s57, s57, s58
    s_add_u32 s57, s57, 2097152
    s_mul_i32 s58, s56, 2080
    s_add_u32 m0, s58, 24960
    s_add_u32 s59, s57, 24576
    buffer_load_dwordx4 v4, s[28:31], s59 offen sc1 lds
    buffer_load_dwordx4 v4, s[28:31], s59 offen offset:1024 sc1 lds
    s_add_u32 m0, s58, 91520
    s_add_u32 s59, s57, 90112
    buffer_load_dwordx4 v4, s[28:31], s59 offen sc1 lds
    buffer_load_dwordx4 v4, s[28:31], s59 offen offset:1024 sc1 lds
    s_add_u32 m0, s58, 33280
    s_add_u32 s59, s57, 32768
    buffer_load_dwordx4 v4, s[28:31], s59 offen sc1 lds
    buffer_load_dwordx4 v4, s[28:31], s59 offen offset:1024 sc1 lds
    s_add_u32 m0, s58, 99840
    s_add_u32 s59, s57, 98304
    buffer_load_dwordx4 v4, s[28:31], s59 offen sc1 lds
    buffer_load_dwordx4 v4, s[28:31], s59 offen offset:1024 sc1 lds
    s_add_u32 m0, s58, 41600
    s_add_u32 s59, s57, 40960
    buffer_load_dwordx4 v4, s[28:31], s59 offen sc1 lds
    buffer_load_dwordx4 v4, s[28:31], s59 offen offset:1024 sc1 lds
    s_add_u32 m0, s58, 108160
    s_add_u32 s59, s57, 106496
    buffer_load_dwordx4 v4, s[28:31], s59 offen sc1 lds
    buffer_load_dwordx4 v4, s[28:31], s59 offen offset:1024 sc1 lds
    s_add_u32 m0, s58, 49920
    s_add_u32 s59, s57, 49152
    buffer_load_dwordx4 v4, s[28:31], s59 offen sc1 lds
    buffer_load_dwordx4 v4, s[28:31], s59 offen offset:1024 sc1 lds
    s_add_u32 m0, s58, 116480
    s_add_u32 s59, s57, 114688
    buffer_load_dwordx4 v4, s[28:31], s59 offen sc1 lds
    buffer_load_dwordx4 v4, s[28:31], s59 offen offset:1024 sc1 lds
    s_add_u32 m0, s58, 58240
    s_add_u32 s59, s57, 57344
    buffer_load_dwordx4 v4, s[28:31], s59 offen sc1 lds
    buffer_load_dwordx4 v4, s[28:31], s59 offen offset:1024 sc1 lds
    s_add_u32 m0, s58, 124800
    s_add_u32 s59, s57, 122880
    buffer_load_dwordx4 v4, s[28:31], s59 offen sc1 lds
    buffer_load_dwordx4 v4, s[28:31], s59 offen offset:1024 sc1 lds
    s_branch concat_heads__mha_block__sliding_local_dilated__prompt_kernel_kvdone
concat_heads__mha_block__sliding_local_dilated__prompt_kernel_gemm:
    s_waitcnt lgkmcnt(0)
    s_mov_b32 s20, s4
    s_mov_b32 s21, s5
    s_mov_b32 s22, 0x200000
    s_mov_b32 s23, 0x20000
    s_mov_b32 s24, s6
    s_mov_b32 s25, s7
    s_mov_b32 s26, 0x180000
    s_mov_b32 s27, 0x20000
    s_mov_b32 s10, s44
    s_mov_b32 s11, s45
    s_mov_b32 s34, s46
    s_mov_b32 s35, s47
    s_mov_b32 s38, s48
    s_mov_b32 s39, s49
    s_mov_b32 s28, s50
    s_mov_b32 s29, s51
    s_mov_b32 s30, 0x1000000
    s_mov_b32 s31, 0x20000
    v_lshlrev_b32 v5, 4, v1
    s_lshl_b32 s42, s2, 3
    s_lshl_b32 s43, s14, 1
    s_add_u32 s42, s42, s43
    s_lshl_b32 s42, s42, 10
    buffer_load_dwordx4 v[252:255], v5, s[20:23], s42 offen
    buffer_load_dwordx4 v[252:255], v5, s[20:23], s42 offen offset:1024
    s_mul_i32 s42, s2, 6144
    s_lshl_b32 s43, s14, 11
    s_add_u32 s42, s42, s43
    s_cmp_ge_u32 s14, 3
    s_cbranch_scc1 concat_heads__mha_block__sliding_local_dilated__prompt_kernel_lin1
    buffer_load_dwordx4 v[252:255], v5, s[24:27], s42 offen
    buffer_load_dwordx4 v[252:255], v5, s[24:27], s42 offen offset:1024
concat_heads__mha_block__sliding_local_dilated__prompt_kernel_lin1:
    v_lshrrev_b32 v5, 1, v2
    v_xor_b32 v5, v3, v5
    v_lshlrev_b32 v6, 7, v2
    v_lshl_add_u32 v16, v5, 4, v6
    v_xor_b32 v5, 4, v5
    v_lshl_add_u32 v17, v5, 4, v6
    v_lshrrev_b32 v5, 2, v2
    v_lshl_add_u32 v6, v3, 3, v5
    v_lshlrev_b32 v6, 7, v6
    v_lshrrev_b32 v5, 1, v5
    v_and_b32 v7, 1, v3
    v_lshl_or_b32 v5, v7, 1, v5
    v_xor_b32 v5, s14, v5
    v_lshl_add_u32 v6, v5, 5, v6
    v_and_b32 v7, 3, v1
    v_lshl_add_u32 v6, v7, 3, v6
    v_add_u32 v20, 81920, v6
    s_mov_b32 s56, 0
    s_mov_b32 s57, 0
    s_mov_b32 s58, 4294895616
    s_mov_b32 s59, 10240
    s_mov_b32 s62, 4294918144
    s_mov_b32 s63, 24576
    v_mov_b32 v96, 0
    v_mov_b32 v97, 0
    v_mov_b32 v98, 0
    v_mov_b32 v99, 0
    v_mov_b32 v100, 0
    v_mov_b32 v101, 0
    v_mov_b32 v102, 0
    v_mov_b32 v103, 0
    v_mov_b32 v104, 0
    v_mov_b32 v105, 0
    v_mov_b32 v106, 0
    v_mov_b32 v107, 0
    v_mov_b32 v108, 0
    v_mov_b32 v109, 0
    v_mov_b32 v110, 0
    v_mov_b32 v111, 0
    v_mov_b32 v112, 0
    v_mov_b32 v113, 0
    v_mov_b32 v114, 0
    v_mov_b32 v115, 0
    v_mov_b32 v116, 0
    v_mov_b32 v117, 0
    v_mov_b32 v118, 0
    v_mov_b32 v119, 0
    v_mov_b32 v120, 0
    v_mov_b32 v121, 0
    v_mov_b32 v122, 0
    v_mov_b32 v123, 0
    v_mov_b32 v124, 0
    v_mov_b32 v125, 0
    v_mov_b32 v126, 0
    v_mov_b32 v127, 0
    v_mov_b32 v128, 0
    v_mov_b32 v129, 0
    v_mov_b32 v130, 0
    v_mov_b32 v131, 0
    v_mov_b32 v132, 0
    v_mov_b32 v133, 0
    v_mov_b32 v134, 0
    v_mov_b32 v135, 0
    v_mov_b32 v136, 0
    v_mov_b32 v137, 0
    v_mov_b32 v138, 0
    v_mov_b32 v139, 0
    v_mov_b32 v140, 0
    v_mov_b32 v141, 0
    v_mov_b32 v142, 0
    v_mov_b32 v143, 0
    v_mov_b32 v144, 0
    v_mov_b32 v145, 0
    v_mov_b32 v146, 0
    v_mov_b32 v147, 0
    v_mov_b32 v148, 0
    v_mov_b32 v149, 0
    v_mov_b32 v150, 0
    v_mov_b32 v151, 0
    v_mov_b32 v152, 0
    v_mov_b32 v153, 0
    v_mov_b32 v154, 0
    v_mov_b32 v155, 0
    v_mov_b32 v156, 0
    v_mov_b32 v157, 0
    v_mov_b32 v158, 0
    v_mov_b32 v159, 0
    v_mov_b32 v160, 0
    v_mov_b32 v161, 0
    v_mov_b32 v162, 0
    v_mov_b32 v163, 0
    v_mov_b32 v164, 0
    v_mov_b32 v165, 0
    v_mov_b32 v166, 0
    v_mov_b32 v167, 0
    v_mov_b32 v168, 0
    v_mov_b32 v169, 0
    v_mov_b32 v170, 0
    v_mov_b32 v171, 0
    v_mov_b32 v172, 0
    v_mov_b32 v173, 0
    v_mov_b32 v174, 0
    v_mov_b32 v175, 0
    v_mov_b32 v176, 0
    v_mov_b32 v177, 0
    v_mov_b32 v178, 0
    v_mov_b32 v179, 0
    v_mov_b32 v180, 0
    v_mov_b32 v181, 0
    v_mov_b32 v182, 0
    v_mov_b32 v183, 0
    v_mov_b32 v184, 0
    v_mov_b32 v185, 0
    v_mov_b32 v186, 0
    v_mov_b32 v187, 0
    v_mov_b32 v188, 0
    v_mov_b32 v189, 0
    v_mov_b32 v190, 0
    v_mov_b32 v191, 0
    v_mov_b32 v192, 0
    v_mov_b32 v193, 0
    v_mov_b32 v194, 0
    v_mov_b32 v195, 0
    v_mov_b32 v196, 0
    v_mov_b32 v197, 0
    v_mov_b32 v198, 0
    v_mov_b32 v199, 0
    s_cmp_lg_u32 s2, 0
    s_cbranch_scc1 concat_heads__mha_block__sliding_local_dilated__prompt_kernel_nonz
    s_cmp_lg_u32 s14, 0
    s_cbranch_scc1 concat_heads__mha_block__sliding_local_dilated__prompt_kernel_nonz
    s_memrealtime s[42:43]
    s_waitcnt lgkmcnt(0)
    s_or_b32 s42, s42, 1
    v_mov_b32 v5, 0
    v_mov_b32 v6, s42
    s_mov_b64 exec, 1
    global_store_dword v5, v6, s[38:39] sc1
    s_mov_b64 exec, -1
concat_heads__mha_block__sliding_local_dilated__prompt_kernel_nonz:
    v_lshlrev_b32 v22, 4, v1
    v_and_b32 v5, 1, v3
    v_lshlrev_b32 v5, 9, v5
    v_lshrrev_b32 v6, 1, v3
    v_lshl_add_u32 v5, v6, 8, v5
    v_lshl_add_u32 v5, v2, 4, v5
    v_add_u32 v21, 1024, v5
    s_lshl_b32 s42, s16, 2
    s_add_u32 s42, s42, s14
    s_lshl_b32 s43, s15, 1
    s_lshl_b32 s44, s42, 16
    s_lshl_b32 s45, s43, 10
    s_add_u32 s44, s44, s45
    s_lshl_b32 s45, s42, 17
    s_lshl_b32 s46, s43, 11
    s_add_u32 s45, s45, s46
    s_add_u32 s45, s45, 2097152
    s_lshl_b32 s47, s42, 8
    s_lshl_b32 s46, s15, 2
    s_add_u32 s47, s47, s46
    s_add_u32 s47, s47, 10485760
    s_mov_b32 s46, 0x3eb8aa3b
    v_and_b32 v8, 31, v1
    v_lshrrev_b32 v9, 5, v1
    v_lshlrev_b32 v9, 2, v9
    v_sub_u32 v9, v8, v9
    v_mov_b32 v10, 0xff800000
    v_subrev_u32 v11, 0, v9
    v_and_b32 v11, 0xfffffff1, v11
    v_cmp_eq_u32 vcc, 0, v11
    s_nop 1
    v_cndmask_b32_e64 v224, v10, 0, vcc
    v_subrev_u32 v11, 1, v9
    v_and_b32 v11, 0xfffffff1, v11
    v_cmp_eq_u32 vcc, 0, v11
    s_nop 1
    v_cndmask_b32_e64 v225, v10, 0, vcc
    v_subrev_u32 v11, 2, v9
    v_and_b32 v11, 0xfffffff1, v11
    v_cmp_eq_u32 vcc, 0, v11
    s_nop 1
    v_cndmask_b32_e64 v226, v10, 0, vcc
    v_subrev_u32 v11, 3, v9
    v_and_b32 v11, 0xfffffff1, v11
    v_cmp_eq_u32 vcc, 0, v11
    s_nop 1
    v_cndmask_b32_e64 v227, v10, 0, vcc
    v_subrev_u32 v11, 8, v9
    v_and_b32 v11, 0xfffffff1, v11
    v_cmp_eq_u32 vcc, 0, v11
    s_nop 1
    v_cndmask_b32_e64 v228, v10, 0, vcc
    v_subrev_u32 v11, 9, v9
    v_and_b32 v11, 0xfffffff1, v11
    v_cmp_eq_u32 vcc, 0, v11
    s_nop 1
    v_cndmask_b32_e64 v229, v10, 0, vcc
    v_subrev_u32 v11, 10, v9
    v_and_b32 v11, 0xfffffff1, v11
    v_cmp_eq_u32 vcc, 0, v11
    s_nop 1
    v_cndmask_b32_e64 v230, v10, 0, vcc
    v_subrev_u32 v11, 11, v9
    v_and_b32 v11, 0xfffffff1, v11
    v_cmp_eq_u32 vcc, 0, v11
    s_nop 1
    v_cndmask_b32_e64 v231, v10, 0, vcc
    v_subrev_u32 v11, 16, v9
    v_and_b32 v11, 0xfffffff1, v11
    v_cmp_eq_u32 vcc, 0, v11
    s_nop 1
    v_cndmask_b32_e64 v232, v10, 0, vcc
    v_subrev_u32 v11, 17, v9
    v_and_b32 v11, 0xfffffff1, v11
    v_cmp_eq_u32 vcc, 0, v11
    s_nop 1
    v_cndmask_b32_e64 v233, v10, 0, vcc
    v_subrev_u32 v11, 18, v9
    v_and_b32 v11, 0xfffffff1, v11
    v_cmp_eq_u32 vcc, 0, v11
    s_nop 1
    v_cndmask_b32_e64 v234, v10, 0, vcc
    v_subrev_u32 v11, 19, v9
    v_and_b32 v11, 0xfffffff1, v11
    v_cmp_eq_u32 vcc, 0, v11
    s_nop 1
    v_cndmask_b32_e64 v235, v10, 0, vcc
    v_subrev_u32 v11, 24, v9
    v_and_b32 v11, 0xfffffff1, v11
    v_cmp_eq_u32 vcc, 0, v11
    s_nop 1
    v_cndmask_b32_e64 v236, v10, 0, vcc
    v_subrev_u32 v11, 25, v9
    v_and_b32 v11, 0xfffffff1, v11
    v_cmp_eq_u32 vcc, 0, v11
    s_nop 1
    v_cndmask_b32_e64 v237, v10, 0, vcc
    v_subrev_u32 v11, 26, v9
    v_and_b32 v11, 0xfffffff1, v11
    v_cmp_eq_u32 vcc, 0, v11
    s_nop 1
    v_cndmask_b32_e64 v238, v10, 0, vcc
    v_subrev_u32 v11, 27, v9
    v_and_b32 v11, 0xfffffff1, v11
    v_cmp_eq_u32 vcc, 0, v11
    s_nop 1
    v_cndmask_b32_e64 v239, v10, 0, vcc
    v_add_u32 v12, 32, v9
    v_subrev_u32 v11, 16, v12
    v_and_b32 v11, 0xfffffff1, v11
    v_cmp_eq_u32 vcc, 0, v11
    s_nop 1
    v_cndmask_b32_e64 v240, v10, 0, vcc
    v_subrev_u32 v11, 17, v12
    v_and_b32 v11, 0xfffffff1, v11
    v_cmp_eq_u32 vcc, 0, v11
    s_nop 1
    v_cndmask_b32_e64 v241, v10, 0, vcc
    v_subrev_u32 v11, 18, v12
    v_and_b32 v11, 0xfffffff1, v11
    v_cmp_eq_u32 vcc, 0, v11
    s_nop 1
    v_cndmask_b32_e64 v242, v10, 0, vcc
    v_subrev_u32 v11, 19, v12
    v_and_b32 v11, 0xfffffff1, v11
    v_cmp_eq_u32 vcc, 0, v11
    s_nop 1
    v_cndmask_b32_e64 v243, v10, 0, vcc
    v_subrev_u32 v11, 24, v12
    v_and_b32 v11, 0xfffffff1, v11
    v_cmp_eq_u32 vcc, 0, v11
    s_nop 1
    v_cndmask_b32_e64 v244, v10, 0, vcc
    v_subrev_u32 v11, 25, v12
    v_and_b32 v11, 0xfffffff1, v11
    v_cmp_eq_u32 vcc, 0, v11
    s_nop 1
    v_cndmask_b32_e64 v245, v10, 0, vcc
    v_subrev_u32 v11, 26, v12
    v_and_b32 v11, 0xfffffff1, v11
    v_cmp_eq_u32 vcc, 0, v11
    s_nop 1
    v_cndmask_b32_e64 v246, v10, 0, vcc
    v_subrev_u32 v11, 27, v12
    v_and_b32 v11, 0xfffffff1, v11
    v_cmp_eq_u32 vcc, 0, v11
    s_nop 1
    v_cndmask_b32_e64 v247, v10, 0, vcc
    s_barrier
    s_mov_b32 s4, s8
    s_mov_b32 s5, s9
    s_mov_b32 s6, 0x200000
    s_mov_b32 s7, 0x20000
    s_mov_b32 s48, s10
    s_mov_b32 s49, s11
    s_mov_b32 s50, 0x180000
    s_mov_b32 s51, 0x20000
    v_lshlrev_b32 v5, 4, v1
    s_lshl_b32 s42, s2, 3
    s_lshl_b32 s43, s14, 1
    s_add_u32 s42, s42, s43
    s_lshl_b32 s42, s42, 10
    buffer_load_dwordx4 v[252:255], v5, s[4:7], s42 offen
    buffer_load_dwordx4 v[252:255], v5, s[4:7], s42 offen offset:1024
    s_mul_i32 s42, s2, 6144
    s_lshl_b32 s43, s14, 11
    s_add_u32 s42, s42, s43
    buffer_load_dwordx4 v[252:255], v5, s[48:51], s42 offen
    buffer_load_dwordx4 v[252:255], v5, s[48:51], s42 offen offset:1024
    s_cmp_eq_u32 s14, 0
    s_cselect_b32 s48, 4, 99
    v_mov_b32 v249, 0
    ds_read_b64_tr_b16 v[52:53], v20 offset:0
    ds_read_b64_tr_b16 v[54:55], v20 offset:512
    ds_read_b128 v[32:35], v16 offset:0
    ds_read_b128 v[36:39], v16 offset:2048
    ds_read_b128 v[40:43], v16 offset:4096
    ds_read_b128 v[44:47], v16 offset:6144
    ds_read_b64_tr_b16 v[56:57], v20 offset:8192
    ds_read_b64_tr_b16 v[58:59], v20 offset:8704
    ds_read_b64_tr_b16 v[60:61], v20 offset:16384
    ds_read_b64_tr_b16 v[62:63], v20 offset:16896
    s_mov_b32 s55, 0
concat_heads__mha_block__sliding_local_dilated__prompt_kernel_gA:
    s_waitcnt lgkmcnt(0)
    v_mfma_f32_16x16x32_bf16 v[96:99], v[52:55], v[32:35], v[96:99]
    ds_read_b64_tr_b16 v[84:85], v20 offset:4096
    v_mfma_f32_16x16x32_bf16 v[100:103], v[52:55], v[36:39], v[100:103]
    ds_read_b64_tr_b16 v[86:87], v20 offset:4608
    ds_read_b128 v[64:67], v17 offset:0
    v_mfma_f32_16x16x32_bf16 v[104:107], v[52:55], v[40:43], v[104:107]
    ds_read_b128 v[68:71], v17 offset:2048
    ds_read_b128 v[72:75], v17 offset:4096
    v_mfma_f32_16x16x32_bf16 v[108:111], v[52:55], v[44:47], v[108:111]
    ds_read_b128 v[76:79], v17 offset:6144
    v_mfma_f32_16x16x32_bf16 v[112:115], v[56:59], v[32:35], v[112:115]
    ds_read_b64_tr_b16 v[88:89], v20 offset:12288
    v_mfma_f32_16x16x32_bf16 v[116:119], v[56:59], v[36:39], v[116:119]
    ds_read_b64_tr_b16 v[90:91], v20 offset:12800
    v_mfma_f32_16x16x32_bf16 v[120:123], v[56:59], v[40:43], v[120:123]
    ds_read_b64_tr_b16 v[92:93], v20 offset:20480
    v_mfma_f32_16x16x32_bf16 v[124:127], v[56:59], v[44:47], v[124:127]
    ds_read_b64_tr_b16 v[94:95], v20 offset:20992
    v_mfma_f32_16x16x32_bf16 v[128:131], v[32:35], v[60:63], v[128:131]
    v_mfma_f32_16x16x32_bf16 v[132:135], v[36:39], v[60:63], v[132:135]
    v_mfma_f32_16x16x32_bf16 v[136:139], v[40:43], v[60:63], v[136:139]
    v_mfma_f32_16x16x32_bf16 v[140:143], v[44:47], v[60:63], v[140:143]
    s_waitcnt lgkmcnt(0)
    v_mfma_f32_16x16x32_bf16 v[96:99], v[84:87], v[64:67], v[96:99]
    s_barrier
    s_cmp_eq_u32 s55, s48
    s_cbranch_scc0 concat_heads__mha_block__sliding_local_dilated__prompt_kernel_gA_nn
    global_load_dword v248, v249, s[38:39] sc1
concat_heads__mha_block__sliding_local_dilated__prompt_kernel_gA_nn:
    s_add_u32 s56, s56, 1
    s_cmp_eq_u32 s56, 8
    s_cselect_b32 s61, s58, s59
    s_cselect_b32 s56, 0, s56
    v_add_u32 v16, s61, v16
    v_add_u32 v17, s61, v17
    s_add_u32 s57, s57, 1
    s_cmp_eq_u32 s57, 3
    s_cselect_b32 s61, s62, s63
    s_cselect_b32 s57, 0, s57
    v_add_u32 v20, s61, v20
    ds_read_b64_tr_b16 v[52:53], v20 offset:0
    v_mfma_f32_16x16x32_bf16 v[100:103], v[84:87], v[68:71], v[100:103]
    ds_read_b64_tr_b16 v[54:55], v20 offset:512
    ds_read_b128 v[32:35], v16 offset:0
    v_mfma_f32_16x16x32_bf16 v[104:107], v[84:87], v[72:75], v[104:107]
    ds_read_b128 v[36:39], v16 offset:2048
    ds_read_b128 v[40:43], v16 offset:4096
    v_mfma_f32_16x16x32_bf16 v[108:111], v[84:87], v[76:79], v[108:111]
    ds_read_b128 v[44:47], v16 offset:6144
    v_mfma_f32_16x16x32_bf16 v[112:115], v[88:91], v[64:67], v[112:115]
    ds_read_b64_tr_b16 v[56:57], v20 offset:8192
    v_mfma_f32_16x16x32_bf16 v[116:119], v[88:91], v[68:71], v[116:119]
    ds_read_b64_tr_b16 v[58:59], v20 offset:8704
    v_mfma_f32_16x16x32_bf16 v[120:123], v[88:91], v[72:75], v[120:123]
    ds_read_b64_tr_b16 v[60:61], v20 offset:16384
    v_mfma_f32_16x16x32_bf16 v[124:127], v[88:91], v[76:79], v[124:127]
    ds_read_b64_tr_b16 v[62:63], v20 offset:16896
    v_mfma_f32_16x16x32_bf16 v[128:131], v[64:67], v[92:95], v[128:131]
    v_mfma_f32_16x16x32_bf16 v[132:135], v[68:71], v[92:95], v[132:135]
    v_mfma_f32_16x16x32_bf16 v[136:139], v[72:75], v[92:95], v[136:139]
    v_mfma_f32_16x16x32_bf16 v[140:143], v[76:79], v[92:95], v[140:143]
    s_add_u32 s55, s55, 1
    s_cmp_lt_u32 s55, 8
    s_cbranch_scc1 concat_heads__mha_block__sliding_local_dilated__prompt_kernel_gA
    ds_read_b128 v[48:51], v16 offset:8192
    s_mov_b32 s55, 0
    s_mov_b32 s13, 0
concat_heads__mha_block__sliding_local_dilated__prompt_kernel_gB:
    s_waitcnt lgkmcnt(0)
    v_mfma_f32_16x16x32_bf16 v[144:147], v[52:55], v[32:35], v[144:147]
    ds_read_b64_tr_b16 v[84:85], v20 offset:4096
    v_mfma_f32_16x16x32_bf16 v[148:151], v[52:55], v[36:39], v[148:151]
    ds_read_b64_tr_b16 v[86:87], v20 offset:4608
    ds_read_b128 v[64:67], v17 offset:0
    v_mfma_f32_16x16x32_bf16 v[152:155], v[52:55], v[40:43], v[152:155]
    ds_read_b128 v[68:71], v17 offset:2048
    ds_read_b128 v[72:75], v17 offset:4096
    v_mfma_f32_16x16x32_bf16 v[156:159], v[52:55], v[44:47], v[156:159]
    ds_read_b128 v[76:79], v17 offset:6144
    v_mfma_f32_16x16x32_bf16 v[160:163], v[56:59], v[32:35], v[160:163]
    ds_read_b64_tr_b16 v[88:89], v20 offset:12288
    v_mfma_f32_16x16x32_bf16 v[164:167], v[56:59], v[36:39], v[164:167]
    ds_read_b64_tr_b16 v[90:91], v20 offset:12800
    v_mfma_f32_16x16x32_bf16 v[168:171], v[56:59], v[40:43], v[168:171]
    ds_read_b64_tr_b16 v[92:93], v20 offset:20480
    v_mfma_f32_16x16x32_bf16 v[172:175], v[56:59], v[44:47], v[172:175]
    ds_read_b64_tr_b16 v[94:95], v20 offset:20992
    v_mfma_f32_16x16x32_bf16 v[176:179], v[32:35], v[60:63], v[176:179]
    ds_read_b128 v[80:83], v17 offset:8192
    v_mfma_f32_16x16x32_bf16 v[180:183], v[36:39], v[60:63], v[180:183]
    v_mfma_f32_16x16x32_bf16 v[184:187], v[40:43], v[60:63], v[184:187]
    v_mfma_f32_16x16x32_bf16 v[188:191], v[44:47], v[60:63], v[188:191]
    v_mfma_f32_16x16x32_bf16 v[192:195], v[56:59], v[48:51], v[192:195]
    v_mfma_f32_16x16x32_bf16 v[196:199], v[48:51], v[60:63], v[196:199]
    s_cmp_ge_u32 s55, 3
    s_cbranch_scc1 concat_heads__mha_block__sliding_local_dilated__prompt_kernel_gB_pdone
    s_cmp_eq_u32 s55, 0
    s_cbranch_scc1 concat_heads__mha_block__sliding_local_dilated__prompt_kernel_gB_p0
    s_cmp_eq_u32 s55, 1
    s_cbranch_scc1 concat_heads__mha_block__sliding_local_dilated__prompt_kernel_gB_p1
    v_mul_f32 v96, s46, v96
    v_mul_f32 v97, s46, v97
    v_mul_f32 v98, s46, v98
    v_mul_f32 v99, s46, v99
    v_mul_f32 v100, s46, v100
    v_mul_f32 v101, s46, v101
    v_mul_f32 v102, s46, v102
    v_mul_f32 v103, s46, v103
    v_cvt_pk_bf16_f32 v216, v96, v97
    v_cvt_pk_bf16_f32 v217, v98, v99
    v_cvt_pk_bf16_f32 v218, v100, v101
    v_cvt_pk_bf16_f32 v219, v102, v103
    s_nop 1
    v_permlane16_swap_b32 v216, v218
    v_permlane16_swap_b32 v217, v219
    buffer_store_dwordx4 v[216:219], v22, s[28:31], s44 offen sc1
    v_mul_f32 v104, s46, v104
    v_mul_f32 v105, s46, v105
    v_mul_f32 v106, s46, v106
    v_mul_f32 v107, s46, v107
    v_mul_f32 v108, s46, v108
    v_mul_f32 v109, s46, v109
    v_mul_f32 v110, s46, v110
    v_mul_f32 v111, s46, v111
    v_cvt_pk_bf16_f32 v220, v104, v105
    v_cvt_pk_bf16_f32 v221, v106, v107
    v_cvt_pk_bf16_f32 v222, v108, v109
    v_cvt_pk_bf16_f32 v223, v110, v111
    s_nop 1
    v_permlane16_swap_b32 v220, v222
    v_permlane16_swap_b32 v221, v223
    buffer_store_dwordx4 v[220:223], v22, s[28:31], s44 offen offset:1024 sc1
    s_branch concat_heads__mha_block__sliding_local_dilated__prompt_kernel_gB_pdone
concat_heads__mha_block__sliding_local_dilated__prompt_kernel_gB_p0:
    v_cvt_pk_bf16_f32 v200, v112, v113
    v_cvt_pk_bf16_f32 v201, v114, v115
    v_cvt_pk_bf16_f32 v202, v116, v117
    v_cvt_pk_bf16_f32 v203, v118, v119
    s_nop 1
    v_permlane16_swap_b32 v200, v202
    v_permlane16_swap_b32 v201, v203
    buffer_store_dwordx4 v[200:203], v22, s[28:31], s45 offen sc1
    v_cvt_pk_bf16_f32 v204, v128, v129
    v_cvt_pk_bf16_f32 v205, v130, v131
    v_cvt_pk_bf16_f32 v206, v132, v133
    v_cvt_pk_bf16_f32 v207, v134, v135
    s_nop 1
    v_permlane16_swap_b32 v204, v206
    v_permlane16_swap_b32 v205, v207
    buffer_store_dwordx4 v[204:207], v21, s[28:31], s45 offen sc1
    s_cmp_lg_u32 s14, 0
    s_cbranch_scc1 concat_heads__mha_block__sliding_local_dilated__prompt_kernel_gB_pdone
    s_mov_b32 s48, 0
    s_waitcnt vmcnt(2)
concat_heads__mha_block__sliding_local_dilated__prompt_kernel_npoll:
    v_readfirstlane_b32 s41, v248
    s_add_u32 s48, s48, 1
    s_cmp_lg_u32 s41, 0
    s_cbranch_scc1 concat_heads__mha_block__sliding_local_dilated__prompt_kernel_ngot
    global_load_dword v248, v249, s[38:39] sc1
    s_waitcnt vmcnt(0)
    s_cmp_lt_u32 s48, 200000
    s_cbranch_scc1 concat_heads__mha_block__sliding_local_dilated__prompt_kernel_npoll
concat_heads__mha_block__sliding_local_dilated__prompt_kernel_ngot:
    v_mov_b32 v5, 163776
    ds_write_b32 v5, v248
    s_branch concat_heads__mha_block__sliding_local_dilated__prompt_kernel_gB_pdone
concat_heads__mha_block__sliding_local_dilated__prompt_kernel_gB_p1:
    v_cvt_pk_bf16_f32 v208, v120, v121
    v_cvt_pk_bf16_f32 v209, v122, v123
    v_cvt_pk_bf16_f32 v210, v124, v125
    v_cvt_pk_bf16_f32 v211, v126, v127
    s_nop 1
    v_permlane16_swap_b32 v208, v210
    v_permlane16_swap_b32 v209, v211
    buffer_store_dwordx4 v[208:211], v22, s[28:31], s45 offen offset:2048 sc1
    v_cvt_pk_bf16_f32 v212, v136, v137
    v_cvt_pk_bf16_f32 v213, v138, v139
    v_cvt_pk_bf16_f32 v214, v140, v141
    v_cvt_pk_bf16_f32 v215, v142, v143
    s_nop 1
    v_permlane16_swap_b32 v212, v214
    v_permlane16_swap_b32 v213, v215
    buffer_store_dwordx4 v[212:215], v21, s[28:31], s45 offen offset:2048 sc1
concat_heads__mha_block__sliding_local_dilated__prompt_kernel_gB_pdone:
    s_waitcnt lgkmcnt(0)
    s_cmp_eq_u32 s55, 5
    s_cbranch_scc0 concat_heads__mha_block__sliding_local_dilated__prompt_kernel_gB_nopub
    v_mov_b32 v5, 163776
    ds_read_b32 v6, v5
    v_mov_b32 v5, 0
    s_waitcnt vmcnt(0) lgkmcnt(0)
    s_mov_b64 exec, 1
    buffer_store_dword v6, v5, s[28:31], s47 offen sc1
    s_mov_b64 exec, -1
concat_heads__mha_block__sliding_local_dilated__prompt_kernel_gB_nopub:
    v_mfma_f32_16x16x32_bf16 v[144:147], v[84:87], v[64:67], v[144:147]
    s_cmp_eq_u32 s55, 7
    s_cbranch_scc1 concat_heads__mha_block__sliding_local_dilated__prompt_kernel_gB_nobar
    s_barrier
concat_heads__mha_block__sliding_local_dilated__prompt_kernel_gB_nobar:
    s_add_u32 s56, s56, 1
    s_cmp_eq_u32 s56, 8
    s_cselect_b32 s61, s58, s59
    s_cselect_b32 s56, 0, s56
    v_add_u32 v16, s61, v16
    v_add_u32 v17, s61, v17
    s_add_u32 s57, s57, 1
    s_cmp_eq_u32 s57, 3
    s_cselect_b32 s61, s62, s63
    s_cselect_b32 s57, 0, s57
    v_add_u32 v20, s61, v20
    ds_read_b64_tr_b16 v[52:53], v20 offset:0
    v_mfma_f32_16x16x32_bf16 v[148:151], v[84:87], v[68:71], v[148:151]
    ds_read_b64_tr_b16 v[54:55], v20 offset:512
    ds_read_b128 v[32:35], v16 offset:0
    v_mfma_f32_16x16x32_bf16 v[152:155], v[84:87], v[72:75], v[152:155]
    ds_read_b128 v[36:39], v16 offset:2048
    ds_read_b128 v[40:43], v16 offset:4096
    v_mfma_f32_16x16x32_bf16 v[156:159], v[84:87], v[76:79], v[156:159]
    ds_read_b128 v[44:47], v16 offset:6144
    v_mfma_f32_16x16x32_bf16 v[160:163], v[88:91], v[64:67], v[160:163]
    ds_read_b64_tr_b16 v[56:57], v20 offset:8192
    v_mfma_f32_16x16x32_bf16 v[164:167], v[88:91], v[68:71], v[164:167]
    ds_read_b64_tr_b16 v[58:59], v20 offset:8704
    v_mfma_f32_16x16x32_bf16 v[168:171], v[88:91], v[72:75], v[168:171]
    ds_read_b64_tr_b16 v[60:61], v20 offset:16384
    v_mfma_f32_16x16x32_bf16 v[172:175], v[88:91], v[76:79], v[172:175]
    ds_read_b64_tr_b16 v[62:63], v20 offset:16896
    v_mfma_f32_16x16x32_bf16 v[176:179], v[64:67], v[92:95], v[176:179]
    ds_read_b128 v[48:51], v16 offset:8192
    v_mfma_f32_16x16x32_bf16 v[180:183], v[68:71], v[92:95], v[180:183]
    v_mfma_f32_16x16x32_bf16 v[184:187], v[72:75], v[92:95], v[184:187]
    v_mfma_f32_16x16x32_bf16 v[188:191], v[76:79], v[92:95], v[188:191]
    v_mfma_f32_16x16x32_bf16 v[192:195], v[88:91], v[80:83], v[192:195]
    v_mfma_f32_16x16x32_bf16 v[196:199], v[80:83], v[92:95], v[196:199]
    s_add_u32 s55, s55, 1
    s_cmp_lt_u32 s55, 8
    s_cbranch_scc1 concat_heads__mha_block__sliding_local_dilated__prompt_kernel_gB
    s_waitcnt lgkmcnt(0)
    s_barrier
    s_mul_i32 s42, s14, 7168
    s_add_u32 s42, s42, 133120
    v_add_u32 v23, s42, v22
    v_subrev_u32 v5, 1024, v21
    v_add_u32 v25, s42, v5
    v_lshrrev_b32 v5, 1, v3
    v_lshlrev_b32 v5, 8, v5
    v_and_b32 v6, 1, v3
    v_lshl_add_u32 v5, v6, 3, v5
    v_lshl_add_u32 v5, v2, 4, v5
    v_add_u32 v26, s42, v5
    s_lshl_b32 s52, s18, 2
    s_add_u32 s52, s52, s14
    s_lshl_b32 s52, s52, 2
    s_lshl_b32 s53, s17, 8
    s_add_u32 s53, s53, s52
    s_add_u32 s49, s53, 10485760
    buffer_load_dword v250, v249, s[28:31], s49 offen sc1
    v_cvt_pk_bf16_f32 v200, v160, v161
    v_cvt_pk_bf16_f32 v201, v162, v163
    v_cvt_pk_bf16_f32 v202, v164, v165
    v_cvt_pk_bf16_f32 v203, v166, v167
    v_cvt_pk_bf16_f32 v204, v176, v177
    v_cvt_pk_bf16_f32 v205, v178, v179
    v_cvt_pk_bf16_f32 v206, v180, v181
    v_cvt_pk_bf16_f32 v207, v182, v183
    v_mul_f32 v144, s46, v144
    v_mul_f32 v145, s46, v145
    v_mul_f32 v146, s46, v146
    v_mul_f32 v147, s46, v147
    v_mul_f32 v148, s46, v148
    v_mul_f32 v149, s46, v149
    v_mul_f32 v150, s46, v150
    v_mul_f32 v151, s46, v151
    v_cvt_pk_bf16_f32 v208, v144, v145
    v_cvt_pk_bf16_f32 v209, v146, v147
    v_cvt_pk_bf16_f32 v210, v148, v149
    v_cvt_pk_bf16_f32 v211, v150, v151
    v_cvt_pk_bf16_f32 v212, v168, v169
    v_cvt_pk_bf16_f32 v213, v170, v171
    v_cvt_pk_bf16_f32 v214, v172, v173
    v_cvt_pk_bf16_f32 v215, v174, v175
    v_cvt_pk_bf16_f32 v216, v184, v185
    v_cvt_pk_bf16_f32 v217, v186, v187
    v_cvt_pk_bf16_f32 v218, v188, v189
    v_cvt_pk_bf16_f32 v219, v190, v191
    v_mul_f32 v152, s46, v152
    v_mul_f32 v153, s46, v153
    v_mul_f32 v154, s46, v154
    v_mul_f32 v155, s46, v155
    v_mul_f32 v156, s46, v156
    v_mul_f32 v157, s46, v157
    v_mul_f32 v158, s46, v158
    v_mul_f32 v159, s46, v159
    v_cvt_pk_bf16_f32 v220, v152, v153
    v_cvt_pk_bf16_f32 v221, v154, v155
    v_cvt_pk_bf16_f32 v222, v156, v157
    v_cvt_pk_bf16_f32 v223, v158, v159
    v_cvt_pk_bf16_f32 v28, v192, v193
    v_cvt_pk_bf16_f32 v29, v194, v195
    v_cvt_pk_bf16_f32 v30, v196, v197
    v_cvt_pk_bf16_f32 v31, v198, v199
    s_nop 0
    v_permlane16_swap_b32 v200, v202
    v_permlane16_swap_b32 v201, v203
    v_permlane16_swap_b32 v204, v206
    v_permlane16_swap_b32 v205, v207
    v_permlane16_swap_b32 v208, v210
    v_permlane16_swap_b32 v209, v211
    v_permlane16_swap_b32 v212, v214
    v_permlane16_swap_b32 v213, v215
    v_permlane16_swap_b32 v216, v218
    v_permlane16_swap_b32 v217, v219
    v_permlane16_swap_b32 v220, v222
    v_permlane16_swap_b32 v221, v223
    ds_write_b128 v23, v[200:203] offset:2560
    ds_write_b128 v25, v[204:207] offset:5120
    ds_write_b128 v23, v[208:211] offset:0
    ds_write_b128 v23, v[212:215] offset:3584
    ds_write_b128 v25, v[216:219] offset:6144
    ds_write_b128 v23, v[220:223] offset:1024
    ds_write_b64 v26, v[28:29] offset:2048
    ds_write_b64 v26, v[30:31] offset:4608
    v_mov_b32 v8, 0x3f803f80
    v_mov_b32 v9, 0x3f803f80
    v_mov_b32 v10, 0x3f803f80
    v_mov_b32 v11, 0x3f803f80
    v_mov_b32 v12, 0
    v_mov_b32 v13, 0
    v_mov_b32 v14, 0
    v_mov_b32 v15, 0
    v_mov_b32 v7, 161792
    ds_write_b128 v7, v[8:11]
    ds_write_b128 v7, v[12:15] offset:16
    v_mov_b32 v7, 163776
    ds_read_b32 v251, v7
    v_and_b32 v2, 31, v1
    v_lshrrev_b32 v3, 5, v1
    v_lshlrev_b32 v4, 4, v1
    v_lshrrev_b32 v5, 2, v2
    v_mov_b32 v6, 0x69
    v_lshrrev_b32 v6, v5, v6
    v_and_b32 v6, 1, v6
    v_cmp_eq_u32 s[42:43], 1, v6
    v_lshlrev_b32 v6, 1, v5
    v_mov_b32 v7, 0x1c80
    v_lshrrev_b32 v6, v6, v7
    v_and_b32 v6, 3, v6
    v_and_b32 v7, 3, v2
    v_lshl_add_u32 v6, v6, 2, v7
    v_lshlrev_b32 v6, 4, v6
    v_lshl_add_u32 v5, v3, 8, v6
    v_cmp_eq_u32 s[44:45], 8, v2
    s_mov_b32 s46, 0
    s_mov_b32 s47, -1
    s_mul_i32 s56, s14, 7168
    s_add_u32 s56, s56, 133120
    v_add_u32 v9, s56, v4
    v_and_b32 v10, 15, v2
    v_lshlrev_b32 v10, 4, v10
    v_lshl_add_u32 v10, v3, 8, v10
    v_add_u32 v10, s56, v10
    v_add_u32 v11, s56, v5
    v_mov_b32 v12, 161808
    v_mov_b32 v13, 161792
    v_cndmask_b32_e64 v12, v12, v13, s[44:45]
    v_add_u32 v13, 4608, v11
    v_cndmask_b32_e64 v16, v12, v13, s[42:43]
    v_add_u32 v13, 5120, v11
    v_cndmask_b32_e64 v17, v12, v13, s[42:43]
    v_add_u32 v13, 5632, v11
    v_cndmask_b32_e64 v18, v12, v13, s[42:43]
    v_add_u32 v13, 6144, v11
    v_cndmask_b32_e64 v19, v12, v13, s[42:43]
    v_add_u32 v13, 6656, v11
    v_cndmask_b32_e64 v20, v12, v13, s[42:43]
    ds_read_b128 v[32:35], v9
    ds_read_b128 v[36:39], v9 offset:2560
    ds_read_b128 v[40:43], v10 offset:2048
    ds_read_b128 v[56:59], v9 offset:1024
    ds_read_b128 v[60:63], v9 offset:3584
    ds_read_b128 v[44:47], v16
    ds_read_b128 v[48:51], v17
    ds_read_b128 v[52:55], v18
    ds_read_b128 v[72:75], v19
    ds_read_b128 v[96:99], v20
    v_mov_b32 v164, 0
    v_mov_b32 v165, 0
    v_mov_b32 v166, 0
    v_mov_b32 v167, 0
    v_mov_b32 v168, 0
    v_mov_b32 v169, 0
    v_mov_b32 v170, 0
    v_mov_b32 v171, 0
    v_mov_b32 v172, 0
    v_mov_b32 v173, 0
    v_mov_b32 v174, 0
    v_mov_b32 v175, 0
    v_mov_b32 v176, 0
    v_mov_b32 v177, 0
    v_mov_b32 v178, 0
    v_mov_b32 v179, 0
    v_mov_b32 v180, 0
    v_mov_b32 v181, 0
    v_mov_b32 v182, 0
    v_mov_b32 v183, 0
    v_mov_b32 v184, 0
    v_mov_b32 v185, 0
    v_mov_b32 v186, 0
    v_mov_b32 v187, 0
    v_mov_b32 v188, 0
    v_mov_b32 v189, 0
    v_mov_b32 v190, 0
    v_mov_b32 v191, 0
    v_mov_b32 v192, 0
    v_mov_b32 v193, 0
    v_mov_b32 v194, 0
    v_mov_b32 v195, 0
    v_mov_b32 v255, 0xdddddddd
    s_waitcnt lgkmcnt(5)
    v_readfirstlane_b32 s41, v251
    v_mfma_f32_32x32x16_bf16 v[100:115], v[36:39], v[32:35], v[224:239]
    v_mfma_f32_32x32x16_bf16 v[132:147], v[60:63], v[56:59], v[224:239]
    v_mfma_f32_32x32x16_bf16 v[148:163], v[36:39], v[56:59], v[232:247]
    s_cmp_eq_u32 s15, 0
    s_cbranch_scc0 concat_heads__mha_block__sliding_local_dilated__prompt_kernel_bl0
    s_nop 7
    v_mov_b32 v240, 0xff800000
    v_mov_b32 v241, 0xff800000
    v_mov_b32 v242, 0xff800000
    v_mov_b32 v243, 0xff800000
    v_mov_b32 v244, 0xff800000
    v_mov_b32 v245, 0xff800000
    v_mov_b32 v246, 0xff800000
    v_mov_b32 v247, 0xff800000
    s_nop 1
concat_heads__mha_block__sliding_local_dilated__prompt_kernel_bl0:
    v_mfma_f32_32x32x16_bf16 v[116:131], v[40:43], v[32:35], v[232:247]
    s_waitcnt vmcnt(0)
    s_mov_b32 s48, 0
concat_heads__mha_block__sliding_local_dilated__prompt_kernel_qpoll:
    v_readfirstlane_b32 s50, v250
    s_add_u32 s48, s48, 1
    s_cmp_eq_u32 s50, s41
    s_cbranch_scc1 concat_heads__mha_block__sliding_local_dilated__prompt_kernel_qgot
    s_sleep 1
    buffer_load_dword v250, v249, s[28:31], s49 offen sc1
    s_waitcnt vmcnt(0)
    s_cmp_lt_u32 s48, 200000
    s_cbranch_scc1 concat_heads__mha_block__sliding_local_dilated__prompt_kernel_qpoll
concat_heads__mha_block__sliding_local_dilated__prompt_kernel_qgot:
    s_and_b32 s52, s14, 3
    s_lshr_b32 s53, s14, 2
    s_lshl_b32 s54, s18, 3
    s_lshl_b32 s55, s52, 1
    s_add_u32 s54, s54, s55
    s_lshl_b32 s55, s17, 16
    s_lshl_b32 s56, s54, 10
    s_add_u32 s55, s55, s56
    buffer_load_dwordx4 v[80:83], v4, s[28:31], s55 offen sc1
    buffer_load_dwordx4 v[76:79], v4, s[28:31], s55 offen offset:1024 sc1
    s_nop 7
    v_max3_f32 v9, v100, v101, v102
    v_max3_f32 v10, v132, v133, v134
    v_max3_f32 v9, v9, v103, v104
    v_max3_f32 v10, v10, v135, v136
    v_max3_f32 v9, v9, v105, v106
    v_max3_f32 v10, v10, v137, v138
    v_max3_f32 v9, v9, v107, v108
    v_max3_f32 v10, v10, v139, v140
    v_max3_f32 v9, v9, v109, v110
    v_max3_f32 v10, v10, v141, v142
    v_max3_f32 v9, v9, v111, v112
    v_max3_f32 v10, v10, v143, v144
    v_max3_f32 v9, v9, v113, v114
    v_max3_f32 v10, v10, v145, v146
    v_max3_f32 v9, v9, v115, v124
    v_max3_f32 v10, v10, v147, v156
    v_max3_f32 v9, v9, v125, v126
    v_max3_f32 v10, v10, v157, v158
    v_max3_f32 v9, v9, v127, v128
    v_max3_f32 v10, v10, v159, v160
    v_max3_f32 v9, v9, v129, v130
    v_max3_f32 v10, v10, v161, v162
    v_max_f32 v9, v9, v131
    v_max_f32 v10, v10, v163
    v_mov_b32 v11, v9
    v_mov_b32 v12, v10
    s_nop 0
    v_permlane32_swap_b32 v9, v11
    v_permlane32_swap_b32 v10, v12
    s_nop 1
    v_max_f32 v9, v9, v11
    v_max_f32 v10, v10, v12
    v_sub_f32 v12, 0, v9
    v_sub_f32 v14, 0, v10
    v_pk_add_f32 v[100:101], v[100:101], v[12:13] op_sel_hi:[1,0]
    v_pk_add_f32 v[102:103], v[102:103], v[12:13] op_sel_hi:[1,0]
    v_pk_add_f32 v[104:105], v[104:105], v[12:13] op_sel_hi:[1,0]
    v_pk_add_f32 v[106:107], v[106:107], v[12:13] op_sel_hi:[1,0]
    v_pk_add_f32 v[108:109], v[108:109], v[12:13] op_sel_hi:[1,0]
    v_pk_add_f32 v[110:111], v[110:111], v[12:13] op_sel_hi:[1,0]
    v_pk_add_f32 v[112:113], v[112:113], v[12:13] op_sel_hi:[1,0]
    v_pk_add_f32 v[114:115], v[114:115], v[12:13] op_sel_hi:[1,0]
    v_pk_add_f32 v[124:125], v[124:125], v[12:13] op_sel_hi:[1,0]
    v_pk_add_f32 v[126:127], v[126:127], v[12:13] op_sel_hi:[1,0]
    v_pk_add_f32 v[128:129], v[128:129], v[12:13] op_sel_hi:[1,0]
    v_pk_add_f32 v[130:131], v[130:131], v[12:13] op_sel_hi:[1,0]
    v_pk_add_f32 v[132:133], v[132:133], v[14:15] op_sel_hi:[1,0]
    v_pk_add_f32 v[134:135], v[134:135], v[14:15] op_sel_hi:[1,0]
    v_pk_add_f32 v[136:137], v[136:137], v[14:15] op_sel_hi:[1,0]
    v_pk_add_f32 v[138:139], v[138:139], v[14:15] op_sel_hi:[1,0]
    v_pk_add_f32 v[140:141], v[140:141], v[14:15] op_sel_hi:[1,0]
    v_pk_add_f32 v[142:143], v[142:143], v[14:15] op_sel_hi:[1,0]
    v_pk_add_f32 v[144:145], v[144:145], v[14:15] op_sel_hi:[1,0]
    v_pk_add_f32 v[146:147], v[146:147], v[14:15] op_sel_hi:[1,0]
    v_pk_add_f32 v[156:157], v[156:157], v[14:15] op_sel_hi:[1,0]
    v_pk_add_f32 v[158:159], v[158:159], v[14:15] op_sel_hi:[1,0]
    v_pk_add_f32 v[160:161], v[160:161], v[14:15] op_sel_hi:[1,0]
    v_pk_add_f32 v[162:163], v[162:163], v[14:15] op_sel_hi:[1,0]
    v_exp_f32 v100, v100
    v_exp_f32 v101, v101
    v_exp_f32 v102, v102
    v_exp_f32 v103, v103
    v_exp_f32 v104, v104
    v_exp_f32 v105, v105
    v_exp_f32 v106, v106
    v_exp_f32 v107, v107
    v_exp_f32 v108, v108
    v_exp_f32 v109, v109
    v_exp_f32 v110, v110
    v_exp_f32 v111, v111
    v_exp_f32 v112, v112
    v_exp_f32 v113, v113
    v_exp_f32 v114, v114
    v_exp_f32 v115, v115
    v_exp_f32 v124, v124
    v_exp_f32 v125, v125
    v_exp_f32 v126, v126
    v_exp_f32 v127, v127
    v_exp_f32 v128, v128
    v_exp_f32 v129, v129
    v_exp_f32 v130, v130
    v_exp_f32 v131, v131
    v_exp_f32 v132, v132
    v_exp_f32 v133, v133
    v_exp_f32 v134, v134
    v_exp_f32 v135, v135
    v_exp_f32 v136, v136
    v_exp_f32 v137, v137
    v_exp_f32 v138, v138
    v_exp_f32 v139, v139
    v_exp_f32 v140, v140
    v_exp_f32 v141, v141
    v_exp_f32 v142, v142
    v_exp_f32 v143, v143
    v_exp_f32 v144, v144
    v_exp_f32 v145, v145
    v_exp_f32 v146, v146
    v_exp_f32 v147, v147
    v_exp_f32 v156, v156
    v_exp_f32 v157, v157
    v_exp_f32 v158, v158
    v_exp_f32 v159, v159
    v_exp_f32 v160, v160
    v_exp_f32 v161, v161
    v_exp_f32 v162, v162
    v_exp_f32 v163, v163
    s_waitcnt lgkmcnt(0)
    v_smfmac_f32_32x32x32_bf16 v[164:179], v[44:47], v[124:131], v255
    v_smfmac_f32_32x32x32_bf16 v[164:179], v[48:51], v[100:107], v255
    v_smfmac_f32_32x32x32_bf16 v[164:179], v[52:55], v[108:115], v255
    v_smfmac_f32_32x32x32_bf16 v[180:195], v[52:55], v[156:163], v255
    v_smfmac_f32_32x32x32_bf16 v[180:195], v[72:75], v[132:139], v255
    v_smfmac_f32_32x32x32_bf16 v[180:195], v[96:99], v[140:147], v255
    s_lshl_b32 s58, s16, 2
    s_add_u32 s58, s58, s14
    s_lshl_b32 s59, s15, 16
    s_lshl_b32 s56, s58, 10
    s_add_u32 s59, s59, s56
    s_add_u32 s59, s59, 8388608
    s_nop 15
    v_cndmask_b32_e64 v16, v164, v168, s[46:47]
    v_cndmask_b32_e64 v20, v176, v172, s[46:47]
    v_cndmask_b32_e64 v17, v165, v169, s[46:47]
    v_cndmask_b32_e64 v21, v177, v173, s[46:47]
    v_cndmask_b32_e64 v18, v166, v170, s[46:47]
    v_cndmask_b32_e64 v22, v178, v174, s[46:47]
    v_cndmask_b32_e64 v19, v167, v171, s[46:47]
    v_cndmask_b32_e64 v23, v179, v175, s[46:47]
    v_mov_b32 v24, v168
    v_mov_b32 v25, v24
    s_nop 1
    v_permlane32_swap_b32 v24, v25
    s_nop 1
    v_rcp_f32 v25, v24
    s_nop 1
    v_mul_f32 v16, v16, v25
    v_mul_f32 v17, v17, v25
    v_mul_f32 v18, v18, v25
    v_mul_f32 v19, v19, v25
    v_mul_f32 v20, v20, v25
    v_mul_f32 v21, v21, v25
    v_mul_f32 v22, v22, v25
    v_mul_f32 v23, v23, v25
    v_cvt_pk_bf16_f32 v28, v16, v17
    v_cvt_pk_bf16_f32 v29, v18, v19
    v_cvt_pk_bf16_f32 v30, v20, v21
    v_cvt_pk_bf16_f32 v31, v22, v23
    buffer_store_dwordx4 v[28:31], v4, s[28:31], s59 offen sc1
    s_add_u32 s59, s59, 32768
    s_nop 1
    v_cndmask_b32_e64 v16, v180, v184, s[46:47]
    v_cndmask_b32_e64 v20, v192, v188, s[46:47]
    v_cndmask_b32_e64 v17, v181, v185, s[46:47]
    v_cndmask_b32_e64 v21, v193, v189, s[46:47]
    v_cndmask_b32_e64 v18, v182, v186, s[46:47]
    v_cndmask_b32_e64 v22, v194, v190, s[46:47]
    v_cndmask_b32_e64 v19, v183, v187, s[46:47]
    v_cndmask_b32_e64 v23, v195, v191, s[46:47]
    v_mov_b32 v24, v184
    v_mov_b32 v25, v24
    s_nop 1
    v_permlane32_swap_b32 v24, v25
    s_nop 1
    v_rcp_f32 v25, v24
    s_nop 1
    v_mul_f32 v16, v16, v25
    v_mul_f32 v17, v17, v25
    v_mul_f32 v18, v18, v25
    v_mul_f32 v19, v19, v25
    v_mul_f32 v20, v20, v25
    v_mul_f32 v21, v21, v25
    v_mul_f32 v22, v22, v25
    v_mul_f32 v23, v23, v25
    v_cvt_pk_bf16_f32 v28, v16, v17
    v_cvt_pk_bf16_f32 v29, v18, v19
    v_cvt_pk_bf16_f32 v30, v20, v21
    v_cvt_pk_bf16_f32 v31, v22, v23
    buffer_store_dwordx4 v[28:31], v4, s[28:31], s59 offen sc1
concat_heads__mha_block__sliding_local_dilated__prompt_kernel_p3:
    v_mov_b32 v108, 0xdddddddd
    v_add_u32 v5, 1024, v5
    s_mul_i32 s58, s53, 66560
    v_add_u32 v110, s58, v4
    v_mov_b32 v9, 2064
    v_mov_b32 v10, 2048
    v_cndmask_b32_e64 v9, v9, v10, s[44:45]
    v_cndmask_b32_e64 v111, v9, v5, s[42:43]
    v_subrev_u32 v9, 512, v9
    v_cndmask_b32_e64 v109, v9, v5, s[42:43]
    v_add_u32 v111, s58, v111
    v_add_u32 v109, s58, v109
    v_mov_b32 v112, 0
    v_mov_b32 v113, 0
    v_mov_b32 v114, 0
    v_mov_b32 v115, 0
    v_mov_b32 v116, 0
    v_mov_b32 v117, 0
    v_mov_b32 v118, 0
    v_mov_b32 v119, 0
    v_mov_b32 v120, 0
    v_mov_b32 v121, 0
    v_mov_b32 v122, 0
    v_mov_b32 v123, 0
    v_mov_b32 v124, 0
    v_mov_b32 v125, 0
    v_mov_b32 v126, 0
    v_mov_b32 v127, 0
    v_mov_b32 v128, 0
    v_mov_b32 v129, 0
    v_mov_b32 v130, 0
    v_mov_b32 v131, 0
    v_mov_b32 v132, 0
    v_mov_b32 v133, 0
    v_mov_b32 v134, 0
    v_mov_b32 v135, 0
    v_mov_b32 v136, 0
    v_mov_b32 v137, 0
    v_mov_b32 v138, 0
    v_mov_b32 v139, 0
    v_mov_b32 v140, 0
    v_mov_b32 v141, 0
    v_mov_b32 v142, 0
    v_mov_b32 v143, 0
    v_mov_b32 v56, 0
    v_mov_b32 v57, 0
    v_mov_b32 v58, 0
    v_mov_b32 v59, 0
    v_mov_b32 v60, 0
    v_mov_b32 v61, 0
    v_mov_b32 v62, 0
    v_mov_b32 v63, 0
    v_mov_b32 v104, 0
    v_mov_b32 v105, 0
    v_mov_b32 v106, 0
    v_mov_b32 v107, 0
    s_cmp_lt_u32 s14, 4
    s_cbranch_scc1 concat_heads__mha_block__sliding_local_dilated__prompt_kernel_w0
    s_waitcnt vmcnt(0) lgkmcnt(0)
    s_branch concat_heads__mha_block__sliding_local_dilated__prompt_kernel_w1
concat_heads__mha_block__sliding_local_dilated__prompt_kernel_w0:
    s_waitcnt vmcnt(2)
concat_heads__mha_block__sliding_local_dilated__prompt_kernel_w1:
    s_barrier
    s_cmp_ge_u32 s14, 4
    s_cbranch_scc1 concat_heads__mha_block__sliding_local_dilated__prompt_kernel_kvrest
concat_heads__mha_block__sliding_local_dilated__prompt_kernel_kvdone:
    ds_read_b128 v[84:87], v110 offset:0
    ds_read_b128 v[88:91], v110 offset:2080
    ds_read_b128 v[92:95], v111 offset:0
    ds_read_b128 v[100:103], v109 offset:512
    s_waitcnt lgkmcnt(0)
    v_mfma_f32_32x32x16_bf16 v[32:47], v[84:87], v[80:83], 0
    s_nop 7
    s_nop 7
    s_mov_b32 s49, 0
    s_cmp_ge_u32 s14, 4
    s_cselect_b32 s63, 2, 99
concat_heads__mha_block__sliding_local_dilated__prompt_kernel_loop:
    v_exp_f32 v32, v32
    v_exp_f32 v33, v33
    v_smfmac_f32_32x32x32_bf16 v[128:143], v[104:107], v[56:63], v108
    ds_read_b128 v[104:107], v109 offset:2592
    v_exp_f32 v34, v34
    v_exp_f32 v35, v35
    v_exp_f32 v36, v36
    v_mfma_f32_32x32x16_bf16 v[48:63], v[84:87], v[76:79], 0
    s_waitcnt lgkmcnt(1)
    v_exp_f32 v37, v37
    v_exp_f32 v38, v38
    v_exp_f32 v39, v39
    v_exp_f32 v40, v40
    v_exp_f32 v41, v41
    v_smfmac_f32_32x32x32_bf16 v[112:127], v[92:95], v[32:39], v108
    ds_read_b128 v[84:87], v110 offset:4160
    v_exp_f32 v42, v42
    v_exp_f32 v43, v43
    v_exp_f32 v44, v44
    v_exp_f32 v45, v45
    v_exp_f32 v46, v46
    v_exp_f32 v47, v47
    v_exp_f32 v48, v48
    v_exp_f32 v49, v49
    v_smfmac_f32_32x32x32_bf16 v[112:127], v[100:103], v[40:47], v108
    ds_read_b128 v[96:99], v111 offset:2080
    v_exp_f32 v50, v50
    v_exp_f32 v51, v51
    v_exp_f32 v52, v52
    v_mfma_f32_32x32x16_bf16 v[32:47], v[88:91], v[80:83], 0
    v_exp_f32 v53, v53
    v_exp_f32 v54, v54
    v_exp_f32 v55, v55
    v_exp_f32 v56, v56
    v_exp_f32 v57, v57
    v_smfmac_f32_32x32x32_bf16 v[128:143], v[92:95], v[48:55], v108
    v_exp_f32 v58, v58
    v_exp_f32 v59, v59
    v_exp_f32 v60, v60
    v_exp_f32 v61, v61
    v_exp_f32 v62, v62
    v_exp_f32 v63, v63
    v_exp_f32 v32, v32
    v_exp_f32 v33, v33
    v_smfmac_f32_32x32x32_bf16 v[128:143], v[100:103], v[56:63], v108
    ds_read_b128 v[100:103], v109 offset:4672
    v_exp_f32 v34, v34
    v_exp_f32 v35, v35
    v_exp_f32 v36, v36
    v_mfma_f32_32x32x16_bf16 v[48:63], v[88:91], v[76:79], 0
    s_waitcnt lgkmcnt(1)
    v_exp_f32 v37, v37
    v_exp_f32 v38, v38
    v_exp_f32 v39, v39
    v_exp_f32 v40, v40
    v_exp_f32 v41, v41
    v_smfmac_f32_32x32x32_bf16 v[112:127], v[96:99], v[32:39], v108
    ds_read_b128 v[88:91], v110 offset:6240
    v_exp_f32 v42, v42
    v_exp_f32 v43, v43
    v_exp_f32 v44, v44
    v_exp_f32 v45, v45
    v_exp_f32 v46, v46
    v_exp_f32 v47, v47
    v_exp_f32 v48, v48
    v_exp_f32 v49, v49
    v_smfmac_f32_32x32x32_bf16 v[112:127], v[104:107], v[40:47], v108
    ds_read_b128 v[92:95], v111 offset:4160
    v_exp_f32 v50, v50
    v_exp_f32 v51, v51
    v_exp_f32 v52, v52
    v_mfma_f32_32x32x16_bf16 v[32:47], v[84:87], v[80:83], 0
    v_exp_f32 v53, v53
    v_exp_f32 v54, v54
    v_exp_f32 v55, v55
    v_exp_f32 v56, v56
    v_exp_f32 v57, v57
    v_smfmac_f32_32x32x32_bf16 v[128:143], v[96:99], v[48:55], v108
    v_exp_f32 v58, v58
    v_exp_f32 v59, v59
    v_exp_f32 v60, v60
    v_exp_f32 v61, v61
    v_exp_f32 v62, v62
    v_exp_f32 v63, v63
    v_exp_f32 v32, v32
    v_exp_f32 v33, v33
    v_smfmac_f32_32x32x32_bf16 v[128:143], v[104:107], v[56:63], v108
    ds_read_b128 v[104:107], v109 offset:6752
    v_exp_f32 v34, v34
    v_exp_f32 v35, v35
    v_exp_f32 v36, v36
    v_mfma_f32_32x32x16_bf16 v[48:63], v[84:87], v[76:79], 0
    s_waitcnt lgkmcnt(1)
    v_exp_f32 v37, v37
    v_exp_f32 v38, v38
    v_exp_f32 v39, v39
    v_exp_f32 v40, v40
    v_exp_f32 v41, v41
    v_smfmac_f32_32x32x32_bf16 v[112:127], v[92:95], v[32:39], v108
    ds_read_b128 v[84:87], v110 offset:8320
    v_exp_f32 v42, v42
    v_exp_f32 v43, v43
    v_exp_f32 v44, v44
    v_exp_f32 v45, v45
    v_exp_f32 v46, v46
    v_exp_f32 v47, v47
    v_exp_f32 v48, v48
    v_exp_f32 v49, v49
    v_smfmac_f32_32x32x32_bf16 v[112:127], v[100:103], v[40:47], v108
    ds_read_b128 v[96:99], v111 offset:6240
    v_exp_f32 v50, v50
    v_exp_f32 v51, v51
    v_exp_f32 v52, v52
    v_mfma_f32_32x32x16_bf16 v[32:47], v[88:91], v[80:83], 0
    v_exp_f32 v53, v53
    v_exp_f32 v54, v54
    v_exp_f32 v55, v55
    v_exp_f32 v56, v56
    v_exp_f32 v57, v57
    v_smfmac_f32_32x32x32_bf16 v[128:143], v[92:95], v[48:55], v108
    v_exp_f32 v58, v58
    v_exp_f32 v59, v59
    v_exp_f32 v60, v60
    v_exp_f32 v61, v61
    v_exp_f32 v62, v62
    v_exp_f32 v63, v63
    v_exp_f32 v32, v32
    v_exp_f32 v33, v33
    v_smfmac_f32_32x32x32_bf16 v[128:143], v[100:103], v[56:63], v108
    ds_read_b128 v[100:103], v109 offset:8832
    v_exp_f32 v34, v34
    v_exp_f32 v35, v35
    v_exp_f32 v36, v36
    v_mfma_f32_32x32x16_bf16 v[48:63], v[88:91], v[76:79], 0
    s_waitcnt lgkmcnt(1)
    v_exp_f32 v37, v37
    v_exp_f32 v38, v38
    v_exp_f32 v39, v39
    v_exp_f32 v40, v40
    v_exp_f32 v41, v41
    v_smfmac_f32_32x32x32_bf16 v[112:127], v[96:99], v[32:39], v108
    ds_read_b128 v[88:91], v110 offset:10400
    v_exp_f32 v42, v42
    v_exp_f32 v43, v43
    v_exp_f32 v44, v44
    v_exp_f32 v45, v45
    v_exp_f32 v46, v46
    v_exp_f32 v47, v47
    v_exp_f32 v48, v48
    v_exp_f32 v49, v49
    v_smfmac_f32_32x32x32_bf16 v[112:127], v[104:107], v[40:47], v108
    ds_read_b128 v[92:95], v111 offset:8320
    v_exp_f32 v50, v50
    v_exp_f32 v51, v51
    v_exp_f32 v52, v52
    v_mfma_f32_32x32x16_bf16 v[32:47], v[84:87], v[80:83], 0
    v_exp_f32 v53, v53
    v_exp_f32 v54, v54
    v_exp_f32 v55, v55
    v_exp_f32 v56, v56
    v_exp_f32 v57, v57
    v_smfmac_f32_32x32x32_bf16 v[128:143], v[96:99], v[48:55], v108
    v_exp_f32 v58, v58
    v_exp_f32 v59, v59
    v_exp_f32 v60, v60
    v_exp_f32 v61, v61
    v_exp_f32 v62, v62
    v_exp_f32 v63, v63
    v_exp_f32 v32, v32
    v_exp_f32 v33, v33
    v_smfmac_f32_32x32x32_bf16 v[128:143], v[104:107], v[56:63], v108
    ds_read_b128 v[104:107], v109 offset:10912
    v_exp_f32 v34, v34
    v_exp_f32 v35, v35
    v_exp_f32 v36, v36
    v_mfma_f32_32x32x16_bf16 v[48:63], v[84:87], v[76:79], 0
    s_waitcnt lgkmcnt(1)
    v_exp_f32 v37, v37
    v_exp_f32 v38, v38
    v_exp_f32 v39, v39
    v_exp_f32 v40, v40
    v_exp_f32 v41, v41
    v_smfmac_f32_32x32x32_bf16 v[112:127], v[92:95], v[32:39], v108
    ds_read_b128 v[84:87], v110 offset:12480
    v_exp_f32 v42, v42
    v_exp_f32 v43, v43
    v_exp_f32 v44, v44
    v_exp_f32 v45, v45
    v_exp_f32 v46, v46
    v_exp_f32 v47, v47
    v_exp_f32 v48, v48
    v_exp_f32 v49, v49
    v_smfmac_f32_32x32x32_bf16 v[112:127], v[100:103], v[40:47], v108
    ds_read_b128 v[96:99], v111 offset:10400
    v_exp_f32 v50, v50
    v_exp_f32 v51, v51
    v_exp_f32 v52, v52
    v_mfma_f32_32x32x16_bf16 v[32:47], v[88:91], v[80:83], 0
    v_exp_f32 v53, v53
    v_exp_f32 v54, v54
    v_exp_f32 v55, v55
    v_exp_f32 v56, v56
    v_exp_f32 v57, v57
    v_smfmac_f32_32x32x32_bf16 v[128:143], v[92:95], v[48:55], v108
    v_exp_f32 v58, v58
    v_exp_f32 v59, v59
    v_exp_f32 v60, v60
    v_exp_f32 v61, v61
    v_exp_f32 v62, v62
    v_exp_f32 v63, v63
    v_exp_f32 v32, v32
    v_exp_f32 v33, v33
    v_smfmac_f32_32x32x32_bf16 v[128:143], v[100:103], v[56:63], v108
    ds_read_b128 v[100:103], v109 offset:12992
    v_exp_f32 v34, v34
    v_exp_f32 v35, v35
    v_exp_f32 v36, v36
    v_mfma_f32_32x32x16_bf16 v[48:63], v[88:91], v[76:79], 0
    s_waitcnt lgkmcnt(1)
    v_exp_f32 v37, v37
    v_exp_f32 v38, v38
    v_exp_f32 v39, v39
    v_exp_f32 v40, v40
    v_exp_f32 v41, v41
    v_smfmac_f32_32x32x32_bf16 v[112:127], v[96:99], v[32:39], v108
    ds_read_b128 v[88:91], v110 offset:14560
    v_exp_f32 v42, v42
    v_exp_f32 v43, v43
    v_exp_f32 v44, v44
    v_exp_f32 v45, v45
    v_exp_f32 v46, v46
    v_exp_f32 v47, v47
    v_exp_f32 v48, v48
    v_exp_f32 v49, v49
    v_smfmac_f32_32x32x32_bf16 v[112:127], v[104:107], v[40:47], v108
    ds_read_b128 v[92:95], v111 offset:12480
    v_exp_f32 v50, v50
    v_exp_f32 v51, v51
    v_exp_f32 v52, v52
    v_mfma_f32_32x32x16_bf16 v[32:47], v[84:87], v[80:83], 0
    v_exp_f32 v53, v53
    v_exp_f32 v54, v54
    v_exp_f32 v55, v55
    v_exp_f32 v56, v56
    v_exp_f32 v57, v57
    v_smfmac_f32_32x32x32_bf16 v[128:143], v[96:99], v[48:55], v108
    v_exp_f32 v58, v58
    v_exp_f32 v59, v59
    v_exp_f32 v60, v60
    v_exp_f32 v61, v61
    v_exp_f32 v62, v62
    v_exp_f32 v63, v63
    v_exp_f32 v32, v32
    v_exp_f32 v33, v33
    v_smfmac_f32_32x32x32_bf16 v[128:143], v[104:107], v[56:63], v108
    ds_read_b128 v[104:107], v109 offset:15072
    v_exp_f32 v34, v34
    v_exp_f32 v35, v35
    v_exp_f32 v36, v36
    v_mfma_f32_32x32x16_bf16 v[48:63], v[84:87], v[76:79], 0
    s_waitcnt lgkmcnt(1)
    v_exp_f32 v37, v37
    v_exp_f32 v38, v38
    v_exp_f32 v39, v39
    v_exp_f32 v40, v40
    v_exp_f32 v41, v41
    v_smfmac_f32_32x32x32_bf16 v[112:127], v[92:95], v[32:39], v108
    ds_read_b128 v[84:87], v110 offset:16640
    v_exp_f32 v42, v42
    v_exp_f32 v43, v43
    v_exp_f32 v44, v44
    v_exp_f32 v45, v45
    v_exp_f32 v46, v46
    v_exp_f32 v47, v47
    v_exp_f32 v48, v48
    v_exp_f32 v49, v49
    v_smfmac_f32_32x32x32_bf16 v[112:127], v[100:103], v[40:47], v108
    ds_read_b128 v[96:99], v111 offset:14560
    v_exp_f32 v50, v50
    v_exp_f32 v51, v51
    v_exp_f32 v52, v52
    v_mfma_f32_32x32x16_bf16 v[32:47], v[88:91], v[80:83], 0
    v_exp_f32 v53, v53
    v_exp_f32 v54, v54
    v_exp_f32 v55, v55
    v_exp_f32 v56, v56
    v_exp_f32 v57, v57
    v_smfmac_f32_32x32x32_bf16 v[128:143], v[92:95], v[48:55], v108
    v_exp_f32 v58, v58
    v_exp_f32 v59, v59
    v_exp_f32 v60, v60
    v_exp_f32 v61, v61
    v_exp_f32 v62, v62
    v_exp_f32 v63, v63
    v_exp_f32 v32, v32
    v_exp_f32 v33, v33
    v_smfmac_f32_32x32x32_bf16 v[128:143], v[100:103], v[56:63], v108
    ds_read_b128 v[100:103], v109 offset:17152
    v_exp_f32 v34, v34
    v_exp_f32 v35, v35
    v_exp_f32 v36, v36
    v_mfma_f32_32x32x16_bf16 v[48:63], v[88:91], v[76:79], 0
    s_waitcnt lgkmcnt(1)
    v_exp_f32 v37, v37
    v_exp_f32 v38, v38
    v_exp_f32 v39, v39
    v_exp_f32 v40, v40
    v_exp_f32 v41, v41
    v_smfmac_f32_32x32x32_bf16 v[112:127], v[96:99], v[32:39], v108
    ds_read_b128 v[88:91], v110 offset:18720
    v_exp_f32 v42, v42
    v_exp_f32 v43, v43
    v_exp_f32 v44, v44
    v_exp_f32 v45, v45
    v_exp_f32 v46, v46
    v_exp_f32 v47, v47
    v_exp_f32 v48, v48
    v_exp_f32 v49, v49
    v_smfmac_f32_32x32x32_bf16 v[112:127], v[104:107], v[40:47], v108
    ds_read_b128 v[92:95], v111 offset:16640
    v_exp_f32 v50, v50
    v_exp_f32 v51, v51
    v_exp_f32 v52, v52
    v_mfma_f32_32x32x16_bf16 v[32:47], v[84:87], v[80:83], 0
    s_add_u32 s49, s49, 1
    v_exp_f32 v53, v53
    v_exp_f32 v54, v54
    v_exp_f32 v55, v55
    v_exp_f32 v56, v56
    v_exp_f32 v57, v57
    v_smfmac_f32_32x32x32_bf16 v[128:143], v[96:99], v[48:55], v108
    s_cmp_eq_u32 s49, 1
    v_exp_f32 v58, v58
    v_exp_f32 v59, v59
    v_exp_f32 v60, v60
    v_exp_f32 v61, v61
    v_exp_f32 v62, v62
    v_exp_f32 v63, v63
    s_cbranch_scc1 concat_heads__mha_block__sliding_local_dilated__prompt_kernel_sync
concat_heads__mha_block__sliding_local_dilated__prompt_kernel_nosync:
    v_add_u32 v110, 16640, v110
    v_add_u32 v111, 16640, v111
    v_add_u32 v109, 16640, v109
    s_cmp_lt_u32 s49, 4
    s_cbranch_scc1 concat_heads__mha_block__sliding_local_dilated__prompt_kernel_loop
    s_waitcnt lgkmcnt(0)
    s_nop 1
    v_smfmac_f32_32x32x32_bf16 v[128:143], v[104:107], v[56:63], v108
    s_nop 15
    s_nop 7
    s_cmp_eq_u32 s53, 0
    s_cbranch_scc1 concat_heads__mha_block__sliding_local_dilated__prompt_kernel_g0
    v_cndmask_b32_e64 v16, v112, v116, s[46:47]
    v_cndmask_b32_e64 v20, v124, v120, s[46:47]
    v_cndmask_b32_e64 v17, v113, v117, s[46:47]
    v_cndmask_b32_e64 v21, v125, v121, s[46:47]
    v_cndmask_b32_e64 v18, v114, v118, s[46:47]
    v_cndmask_b32_e64 v22, v126, v122, s[46:47]
    v_cndmask_b32_e64 v19, v115, v119, s[46:47]
    v_cndmask_b32_e64 v23, v127, v123, s[46:47]
    v_mov_b32 v24, v116
    s_mul_i32 s59, s14, 2304
    s_add_u32 s59, s59, 133120
    v_add_u32 v9, s59, v4
    v_lshrrev_b32 v10, 2, v4
    v_add_u32 v10, s59, v10
    ds_write_b128 v9, v[16:19]
    ds_write_b128 v9, v[20:23] offset:1024
    ds_write_b32 v10, v24 offset:2048
    v_mov_b32 v112, v128
    v_mov_b32 v113, v129
    v_mov_b32 v114, v130
    v_mov_b32 v115, v131
    v_mov_b32 v116, v132
    v_mov_b32 v117, v133
    v_mov_b32 v118, v134
    v_mov_b32 v119, v135
    v_mov_b32 v120, v136
    v_mov_b32 v121, v137
    v_mov_b32 v122, v138
    v_mov_b32 v123, v139
    v_mov_b32 v124, v140
    v_mov_b32 v125, v141
    v_mov_b32 v126, v142
    v_mov_b32 v127, v143
    v_mov_b32 v80, v76
    v_mov_b32 v81, v77
    v_mov_b32 v82, v78
    v_mov_b32 v83, v79
    s_branch concat_heads__mha_block__sliding_local_dilated__prompt_kernel_g1
concat_heads__mha_block__sliding_local_dilated__prompt_kernel_g0:
    v_cndmask_b32_e64 v16, v128, v132, s[46:47]
    v_cndmask_b32_e64 v20, v140, v136, s[46:47]
    v_cndmask_b32_e64 v17, v129, v133, s[46:47]
    v_cndmask_b32_e64 v21, v141, v137, s[46:47]
    v_cndmask_b32_e64 v18, v130, v134, s[46:47]
    v_cndmask_b32_e64 v22, v142, v138, s[46:47]
    v_cndmask_b32_e64 v19, v131, v135, s[46:47]
    v_cndmask_b32_e64 v23, v143, v139, s[46:47]
    v_mov_b32 v24, v132
    s_mul_i32 s59, s14, 2304
    s_add_u32 s59, s59, 133120
    v_add_u32 v9, s59, v4
    v_lshrrev_b32 v10, 2, v4
    v_add_u32 v10, s59, v10
    ds_write_b128 v9, v[16:19]
    ds_write_b128 v9, v[20:23] offset:1024
    ds_write_b32 v10, v24 offset:2048
    s_waitcnt lgkmcnt(0)
    v_mov_b32 v6, 163760
    v_mov_b32 v7, 1
    s_mov_b64 exec, 1
    ds_add_u32 v6, v7
    s_mov_b64 exec, -1
concat_heads__mha_block__sliding_local_dilated__prompt_kernel_s1:
    ds_read_b32 v7, v6
    s_waitcnt lgkmcnt(0)
    v_readfirstlane_b32 s59, v7
    s_cmp_ge_u32 s59, 4
    s_cbranch_scc1 concat_heads__mha_block__sliding_local_dilated__prompt_kernel_s1_ok
    s_sleep 2
    s_branch concat_heads__mha_block__sliding_local_dilated__prompt_kernel_s1
concat_heads__mha_block__sliding_local_dilated__prompt_kernel_s1_ok:
    v_lshrrev_b32 v6, 3, v1
    v_and_b32 v7, 7, v1
    v_bfe_u32 v8, v1, 4, 1
    v_lshlrev_b32 v8, 2, v8
    v_xor_b32 v7, v7, v8
    v_lshlrev_b32 v6, 10, v6
    v_lshl_add_u32 v12, v7, 4, v6
    s_mov_b32 s20, s32
    s_mov_b32 s21, s33
    s_mov_b32 s22, 0x80000
    s_mov_b32 s23, 0x20000
    s_and_b32 s57, s14, 3
    s_lshl_b32 s55, s40, 7
    s_lshl_b32 s56, s57, 13
    s_add_u32 s55, s55, s56
    s_lshl_b32 s56, s57, 10
    s_add_u32 m0, s56, 0
    s_add_u32 s57, s55, 0
    buffer_load_dwordx4 v12, s[20:23], s57 offen lds
    s_add_u32 m0, s56, 4096
    s_add_u32 s57, s55, 32768
    buffer_load_dwordx4 v12, s[20:23], s57 offen lds
    s_add_u32 m0, s56, 8192
    s_add_u32 s57, s55, 65536
    buffer_load_dwordx4 v12, s[20:23], s57 offen lds
    s_add_u32 m0, s56, 12288
    s_add_u32 s57, s55, 98304
    buffer_load_dwordx4 v12, s[20:23], s57 offen lds
    s_add_u32 m0, s56, 16384
    s_add_u32 s57, s55, 131072
    buffer_load_dwordx4 v12, s[20:23], s57 offen lds
    s_add_u32 m0, s56, 20480
    s_add_u32 s57, s55, 163840
    buffer_load_dwordx4 v12, s[20:23], s57 offen lds
    s_add_u32 m0, s56, 24576
    s_add_u32 s57, s55, 196608
    buffer_load_dwordx4 v12, s[20:23], s57 offen lds
    s_add_u32 m0, s56, 28672
    s_add_u32 s57, s55, 229376
    buffer_load_dwordx4 v12, s[20:23], s57 offen lds
    s_add_u32 m0, s56, 32768
    s_add_u32 s57, s55, 262144
    buffer_load_dwordx4 v12, s[20:23], s57 offen lds
    s_add_u32 m0, s56, 36864
    s_add_u32 s57, s55, 294912
    buffer_load_dwordx4 v12, s[20:23], s57 offen lds
    s_add_u32 m0, s56, 40960
    s_add_u32 s57, s55, 327680
    buffer_load_dwordx4 v12, s[20:23], s57 offen lds
    s_add_u32 m0, s56, 45056
    s_add_u32 s57, s55, 360448
    buffer_load_dwordx4 v12, s[20:23], s57 offen lds
    s_add_u32 m0, s56, 49152
    s_add_u32 s57, s55, 393216
    buffer_load_dwordx4 v12, s[20:23], s57 offen lds
    s_add_u32 m0, s56, 53248
    s_add_u32 s57, s55, 425984
    buffer_load_dwordx4 v12, s[20:23], s57 offen lds
    s_add_u32 m0, s56, 57344
    s_add_u32 s57, s55, 458752
    buffer_load_dwordx4 v12, s[20:23], s57 offen lds
    s_add_u32 m0, s56, 61440
    s_add_u32 s57, s55, 491520
    buffer_load_dwordx4 v12, s[20:23], s57 offen lds
    s_lshl_b32 s58, s19, 8
    s_add_u32 s58, s58, 10502144
    v_lshlrev_b32 v9, 2, v1
    s_mov_b32 s49, 0
concat_heads__mha_block__sliding_local_dilated__prompt_kernel_pB:
    buffer_load_dword v10, v9, s[28:31], s58 offen sc1
    s_waitcnt vmcnt(0)
    v_cmp_eq_u32 vcc, s41, v10
    s_add_u32 s49, s49, 1
    s_nop 2
    s_cmp_eq_u64 vcc, exec
    s_cbranch_scc1 concat_heads__mha_block__sliding_local_dilated__prompt_kernel_pB_got
    s_sleep 1
    s_cmp_lt_u32 s49, 200000
    s_cbranch_scc1 concat_heads__mha_block__sliding_local_dilated__prompt_kernel_pB
concat_heads__mha_block__sliding_local_dilated__prompt_kernel_pB_got:
    s_and_b32 s55, s14, 1
    s_lshl_b32 s56, s19, 1
    s_add_u32 s55, s55, s56
    s_lshl_b32 s56, s55, 15
    s_add_u32 s56, s56, 8388608
    buffer_load_dwordx4 v[128:131], v4, s[28:31], s56 offen offset:0 sc1
    buffer_load_dwordx4 v[132:135], v4, s[28:31], s56 offen offset:1024 sc1
    buffer_load_dwordx4 v[136:139], v4, s[28:31], s56 offen offset:2048 sc1
    buffer_load_dwordx4 v[140:143], v4, s[28:31], s56 offen offset:3072 sc1
    s_add_u32 s56, s56, 4096
    buffer_load_dwordx4 v[144:147], v4, s[28:31], s56 offen offset:0 sc1
    buffer_load_dwordx4 v[148:151], v4, s[28:31], s56 offen offset:1024 sc1
    buffer_load_dwordx4 v[152:155], v4, s[28:31], s56 offen offset:2048 sc1
    buffer_load_dwordx4 v[156:159], v4, s[28:31], s56 offen offset:3072 sc1
    s_add_u32 s56, s56, 4096
    buffer_load_dwordx4 v[160:163], v4, s[28:31], s56 offen offset:0 sc1
    buffer_load_dwordx4 v[164:167], v4, s[28:31], s56 offen offset:1024 sc1
    buffer_load_dwordx4 v[168:171], v4, s[28:31], s56 offen offset:2048 sc1
    buffer_load_dwordx4 v[172:175], v4, s[28:31], s56 offen offset:3072 sc1
    s_add_u32 s56, s56, 4096
    buffer_load_dwordx4 v[176:179], v4, s[28:31], s56 offen offset:0 sc1
    buffer_load_dwordx4 v[180:183], v4, s[28:31], s56 offen offset:1024 sc1
    buffer_load_dwordx4 v[184:187], v4, s[28:31], s56 offen offset:2048 sc1
    buffer_load_dwordx4 v[188:191], v4, s[28:31], s56 offen offset:3072 sc1
    s_add_u32 s56, s56, 4096
    buffer_load_dwordx4 v[192:195], v4, s[28:31], s56 offen offset:0 sc1
    buffer_load_dwordx4 v[196:199], v4, s[28:31], s56 offen offset:1024 sc1
    buffer_load_dwordx4 v[200:203], v4, s[28:31], s56 offen offset:2048 sc1
    buffer_load_dwordx4 v[204:207], v4, s[28:31], s56 offen offset:3072 sc1
    s_add_u32 s56, s56, 4096
    buffer_load_dwordx4 v[208:211], v4, s[28:31], s56 offen offset:0 sc1
    buffer_load_dwordx4 v[212:215], v4, s[28:31], s56 offen offset:1024 sc1
    buffer_load_dwordx4 v[216:219], v4, s[28:31], s56 offen offset:2048 sc1
    buffer_load_dwordx4 v[220:223], v4, s[28:31], s56 offen offset:3072 sc1
    s_add_u32 s56, s56, 4096
    buffer_load_dwordx4 v[224:227], v4, s[28:31], s56 offen offset:0 sc1
    buffer_load_dwordx4 v[228:231], v4, s[28:31], s56 offen offset:1024 sc1
    buffer_load_dwordx4 v[232:235], v4, s[28:31], s56 offen offset:2048 sc1
    buffer_load_dwordx4 v[236:239], v4, s[28:31], s56 offen offset:3072 sc1
    s_add_u32 s56, s56, 4096
    buffer_load_dwordx4 v[240:243], v4, s[28:31], s56 offen offset:0 sc1
    buffer_load_dwordx4 v[244:247], v4, s[28:31], s56 offen offset:1024 sc1
    buffer_load_dwordx4 v[248:251], v4, s[28:31], s56 offen offset:2048 sc1
    buffer_load_dwordx4 v[252:255], v4, s[28:31], s56 offen offset:3072 sc1
    s_waitcnt vmcnt(0)
concat_heads__mha_block__sliding_local_dilated__prompt_kernel_g1:
    s_xor_b32 s59, s14, 4
    s_mul_i32 s59, s59, 2304
    s_add_u32 s59, s59, 133120
    v_add_u32 v9, s59, v4
    v_lshrrev_b32 v10, 2, v4
    v_add_u32 v10, s59, v10
    s_waitcnt lgkmcnt(0)
    s_barrier
    ds_read_b128 v[40:43], v9
    ds_read_b128 v[44:47], v9 offset:1024
    ds_read_b32 v48, v10 offset:2048
    v_cndmask_b32_e64 v16, v112, v116, s[46:47]
    v_cndmask_b32_e64 v20, v124, v120, s[46:47]
    v_cndmask_b32_e64 v17, v113, v117, s[46:47]
    v_cndmask_b32_e64 v21, v125, v121, s[46:47]
    v_cndmask_b32_e64 v18, v114, v118, s[46:47]
    v_cndmask_b32_e64 v22, v126, v122, s[46:47]
    v_cndmask_b32_e64 v19, v115, v119, s[46:47]
    v_cndmask_b32_e64 v23, v127, v123, s[46:47]
    v_mov_b32 v24, v116
    s_waitcnt lgkmcnt(0)
    s_barrier
    v_add_f32 v16, v16, v40
    v_add_f32 v17, v17, v41
    v_add_f32 v18, v18, v42
    v_add_f32 v19, v19, v43
    v_add_f32 v20, v20, v44
    v_add_f32 v21, v21, v45
    v_add_f32 v22, v22, v46
    v_add_f32 v23, v23, v47
    v_add_f32 v24, v24, v48
    v_mov_b32 v25, v24
    s_nop 1
    v_permlane32_swap_b32 v24, v25
    s_nop 1
    s_add_u32 s54, s54, s53
    s_lshl_b32 s56, s54, 15
    s_lshl_b32 s57, s17, 10
    s_add_u32 s56, s56, s57
    s_add_u32 s56, s56, 6291456
    v_mov_b32 v26, 0
    v_fmac_f32 v26, 0, v16
    v_fmac_f32 v26, 0, v17
    v_fmac_f32 v26, 0, v18
    v_fmac_f32 v26, 0, v19
    v_fmac_f32 v26, 0, v20
    v_fmac_f32 v26, 0, v21
    v_fmac_f32 v26, 0, v22
    v_fmac_f32 v26, 0, v23
    v_add_f32 v26, v26, v24
    v_mov_b32 v27, 0x21800000
    v_cmp_ge_f32 s[50:51], v26, v27
    v_mov_b32 v27, 0x5d800000
    v_cmp_le_f32 vcc, v26, v27
    s_nop 3
    s_and_b64 vcc, vcc, s[50:51]
    s_cmp_eq_u64 vcc, exec
    s_cbranch_scc0 concat_heads__mha_block__sliding_local_dilated__prompt_kernel_fallback
concat_heads__mha_block__sliding_local_dilated__prompt_kernel_store:
    v_rcp_f32 v25, v24
    s_nop 1
    v_mul_f32 v16, v16, v25
    v_mul_f32 v17, v17, v25
    v_mul_f32 v18, v18, v25
    v_mul_f32 v19, v19, v25
    v_mul_f32 v20, v20, v25
    v_mul_f32 v21, v21, v25
    v_mul_f32 v22, v22, v25
    v_mul_f32 v23, v23, v25
    v_cvt_pk_bf16_f32 v28, v16, v17
    v_cvt_pk_bf16_f32 v29, v18, v19
    v_cvt_pk_bf16_f32 v30, v20, v21
    v_cvt_pk_bf16_f32 v31, v22, v23
    buffer_store_dwordx4 v[28:31], v4, s[28:31], s56 offen sc1
    s_lshr_b32 s48, s54, 1
    s_lshl_b32 s48, s48, 8
    s_and_b32 s57, s54, 1
    s_lshl_b32 s57, s57, 5
    s_add_u32 s57, s57, s17
    s_lshl_b32 s57, s57, 2
    s_add_u32 s48, s48, s57
    s_add_u32 s48, s48, 10518528
    s_cmp_ge_u32 s14, 4
    s_cbranch_scc1 concat_heads__mha_block__sliding_local_dilated__prompt_kernel_t47
    s_waitcnt vmcnt(0)
    v_mov_b32 v9, 0
    v_mov_b32 v10, s41
    s_mov_b64 exec, 1
    buffer_store_dword v10, v9, s[28:31], s48 offen offset:0 sc1
    s_mov_b64 exec, -1
    v_lshrrev_b32 v6, 3, v1
    v_and_b32 v7, 7, v1
    v_bfe_u32 v8, v1, 4, 1
    v_lshlrev_b32 v8, 2, v8
    v_xor_b32 v7, v7, v8
    v_lshlrev_b32 v6, 10, v6
    v_lshl_add_u32 v12, v7, 4, v6
    s_mov_b32 s20, s34
    s_mov_b32 s21, s35
    s_mov_b32 s22, 0x80000
    s_mov_b32 s23, 0x20000
    s_and_b32 s57, s14, 3
    s_lshl_b32 s55, s40, 7
    s_lshl_b32 s56, s57, 13
    s_add_u32 s55, s55, s56
    s_lshl_b32 s56, s57, 10
    s_add_u32 m0, s56, 66560
    s_add_u32 s57, s55, 0
    buffer_load_dwordx4 v12, s[20:23], s57 offen lds
    s_add_u32 m0, s56, 70656
    s_add_u32 s57, s55, 32768
    buffer_load_dwordx4 v12, s[20:23], s57 offen lds
    s_add_u32 m0, s56, 74752
    s_add_u32 s57, s55, 65536
    buffer_load_dwordx4 v12, s[20:23], s57 offen lds
    s_add_u32 m0, s56, 78848
    s_add_u32 s57, s55, 98304
    buffer_load_dwordx4 v12, s[20:23], s57 offen lds
    s_add_u32 m0, s56, 82944
    s_add_u32 s57, s55, 131072
    buffer_load_dwordx4 v12, s[20:23], s57 offen lds
    s_add_u32 m0, s56, 87040
    s_add_u32 s57, s55, 163840
    buffer_load_dwordx4 v12, s[20:23], s57 offen lds
    s_add_u32 m0, s56, 91136
    s_add_u32 s57, s55, 196608
    buffer_load_dwordx4 v12, s[20:23], s57 offen lds
    s_add_u32 m0, s56, 95232
    s_add_u32 s57, s55, 229376
    buffer_load_dwordx4 v12, s[20:23], s57 offen lds
    s_add_u32 m0, s56, 99328
    s_add_u32 s57, s55, 262144
    buffer_load_dwordx4 v12, s[20:23], s57 offen lds
    s_add_u32 m0, s56, 103424
    s_add_u32 s57, s55, 294912
    buffer_load_dwordx4 v12, s[20:23], s57 offen lds
    s_add_u32 m0, s56, 107520
    s_add_u32 s57, s55, 327680
    buffer_load_dwordx4 v12, s[20:23], s57 offen lds
    s_add_u32 m0, s56, 111616
    s_add_u32 s57, s55, 360448
    buffer_load_dwordx4 v12, s[20:23], s57 offen lds
    s_add_u32 m0, s56, 115712
    s_add_u32 s57, s55, 393216
    buffer_load_dwordx4 v12, s[20:23], s57 offen lds
    s_add_u32 m0, s56, 119808
    s_add_u32 s57, s55, 425984
    buffer_load_dwordx4 v12, s[20:23], s57 offen lds
    s_add_u32 m0, s56, 123904
    s_add_u32 s57, s55, 458752
    buffer_load_dwordx4 v12, s[20:23], s57 offen lds
    s_add_u32 m0, s56, 128000
    s_add_u32 s57, s55, 491520
    buffer_load_dwordx4 v12, s[20:23], s57 offen lds
    v_lshrrev_b32 v13, 5, v1
    v_bfe_u32 v14, v1, 2, 2
    v_lshl_add_u32 v6, v13, 3, v14
    v_lshlrev_b32 v6, 7, v6
    v_bfe_u32 v7, v1, 4, 1
    v_lshl_add_u32 v6, v7, 5, v6
    v_and_b32 v7, 3, v1
    v_lshl_add_u32 v6, v7, 3, v6
    s_lshr_b32 s57, s14, 1
    v_lshrrev_b32 v7, 1, v14
    v_xor_b32 v7, s57, v7
    v_lshl_add_u32 v16, v7, 6, v6
    v_add_u32 v16, 66560, v16
    s_waitcnt vmcnt(0)
    v_mov_b32 v6, 163764
    v_mov_b32 v7, 1
    s_mov_b64 exec, 1
    ds_add_u32 v6, v7
    s_mov_b64 exec, -1
concat_heads__mha_block__sliding_local_dilated__prompt_kernel_s2:
    ds_read_b32 v7, v6
    s_waitcnt lgkmcnt(0)
    v_readfirstlane_b32 s59, v7
    s_cmp_ge_u32 s59, 4
    s_cbranch_scc1 concat_heads__mha_block__sliding_local_dilated__prompt_kernel_s2_ok
    s_sleep 2
    s_branch concat_heads__mha_block__sliding_local_dilated__prompt_kernel_s2
concat_heads__mha_block__sliding_local_dilated__prompt_kernel_s2_ok:
    ds_read_b64_tr_b16 v[32:33], v16 offset:0
    ds_read_b64_tr_b16 v[34:35], v16 offset:512
    ds_read_b64_tr_b16 v[36:37], v16 offset:2048
    ds_read_b64_tr_b16 v[38:39], v16 offset:2560
    s_waitcnt lgkmcnt(2)
    v_mfma_f32_32x32x16_bf16 v[48:63], v[32:35], v[128:131], 0
    ds_read_b64_tr_b16 v[32:33], v16 offset:4096
    ds_read_b64_tr_b16 v[34:35], v16 offset:4608
    s_waitcnt lgkmcnt(2)
    v_mfma_f32_32x32x16_bf16 v[48:63], v[36:39], v[132:135], v[48:63]
    ds_read_b64_tr_b16 v[36:37], v16 offset:6144
    ds_read_b64_tr_b16 v[38:39], v16 offset:6656
    s_waitcnt lgkmcnt(2)
    v_mfma_f32_32x32x16_bf16 v[48:63], v[32:35], v[136:139], v[48:63]
    ds_read_b64_tr_b16 v[32:33], v16 offset:8192
    ds_read_b64_tr_b16 v[34:35], v16 offset:8704
    s_waitcnt lgkmcnt(2)
    v_mfma_f32_32x32x16_bf16 v[48:63], v[36:39], v[140:143], v[48:63]
    ds_read_b64_tr_b16 v[36:37], v16 offset:10240
    ds_read_b64_tr_b16 v[38:39], v16 offset:10752
    s_waitcnt lgkmcnt(2)
    v_mfma_f32_32x32x16_bf16 v[48:63], v[32:35], v[144:147], v[48:63]
    ds_read_b64_tr_b16 v[32:33], v16 offset:12288
    ds_read_b64_tr_b16 v[34:35], v16 offset:12800
    s_waitcnt lgkmcnt(2)
    v_mfma_f32_32x32x16_bf16 v[48:63], v[36:39], v[148:151], v[48:63]
    ds_read_b64_tr_b16 v[36:37], v16 offset:14336
    ds_read_b64_tr_b16 v[38:39], v16 offset:14848
    s_waitcnt lgkmcnt(2)
    v_mfma_f32_32x32x16_bf16 v[48:63], v[32:35], v[152:155], v[48:63]
    ds_read_b64_tr_b16 v[32:33], v16 offset:16384
    ds_read_b64_tr_b16 v[34:35], v16 offset:16896
    s_waitcnt lgkmcnt(2)
    v_mfma_f32_32x32x16_bf16 v[48:63], v[36:39], v[156:159], v[48:63]
    ds_read_b64_tr_b16 v[36:37], v16 offset:18432
    ds_read_b64_tr_b16 v[38:39], v16 offset:18944
    s_waitcnt lgkmcnt(2)
    v_mfma_f32_32x32x16_bf16 v[48:63], v[32:35], v[160:163], v[48:63]
    ds_read_b64_tr_b16 v[32:33], v16 offset:20480
    ds_read_b64_tr_b16 v[34:35], v16 offset:20992
    s_waitcnt lgkmcnt(2)
    v_mfma_f32_32x32x16_bf16 v[48:63], v[36:39], v[164:167], v[48:63]
    ds_read_b64_tr_b16 v[36:37], v16 offset:22528
    ds_read_b64_tr_b16 v[38:39], v16 offset:23040
    s_waitcnt lgkmcnt(2)
    v_mfma_f32_32x32x16_bf16 v[48:63], v[32:35], v[168:171], v[48:63]
    ds_read_b64_tr_b16 v[32:33], v16 offset:24576
    ds_read_b64_tr_b16 v[34:35], v16 offset:25088
    s_waitcnt lgkmcnt(2)
    v_mfma_f32_32x32x16_bf16 v[48:63], v[36:39], v[172:175], v[48:63]
    ds_read_b64_tr_b16 v[36:37], v16 offset:26624
    ds_read_b64_tr_b16 v[38:39], v16 offset:27136
    s_waitcnt lgkmcnt(2)
    v_mfma_f32_32x32x16_bf16 v[48:63], v[32:35], v[176:179], v[48:63]
    ds_read_b64_tr_b16 v[32:33], v16 offset:28672
    ds_read_b64_tr_b16 v[34:35], v16 offset:29184
    s_waitcnt lgkmcnt(2)
    v_mfma_f32_32x32x16_bf16 v[48:63], v[36:39], v[180:183], v[48:63]
    ds_read_b64_tr_b16 v[36:37], v16 offset:30720
    ds_read_b64_tr_b16 v[38:39], v16 offset:31232
    s_waitcnt lgkmcnt(2)
    v_mfma_f32_32x32x16_bf16 v[48:63], v[32:35], v[184:187], v[48:63]
    ds_read_b64_tr_b16 v[32:33], v16 offset:32768
    ds_read_b64_tr_b16 v[34:35], v16 offset:33280
    s_waitcnt lgkmcnt(2)
    v_mfma_f32_32x32x16_bf16 v[48:63], v[36:39], v[188:191], v[48:63]
    ds_read_b64_tr_b16 v[36:37], v16 offset:34816
    ds_read_b64_tr_b16 v[38:39], v16 offset:35328
    s_waitcnt lgkmcnt(2)
    v_mfma_f32_32x32x16_bf16 v[48:63], v[32:35], v[192:195], v[48:63]
    ds_read_b64_tr_b16 v[32:33], v16 offset:36864
    ds_read_b64_tr_b16 v[34:35], v16 offset:37376
    s_waitcnt lgkmcnt(2)
    v_mfma_f32_32x32x16_bf16 v[48:63], v[36:39], v[196:199], v[48:63]
    ds_read_b64_tr_b16 v[36:37], v16 offset:38912
    ds_read_b64_tr_b16 v[38:39], v16 offset:39424
    s_waitcnt lgkmcnt(2)
    v_mfma_f32_32x32x16_bf16 v[48:63], v[32:35], v[200:203], v[48:63]
    ds_read_b64_tr_b16 v[32:33], v16 offset:40960
    ds_read_b64_tr_b16 v[34:35], v16 offset:41472
    s_waitcnt lgkmcnt(2)
    v_mfma_f32_32x32x16_bf16 v[48:63], v[36:39], v[204:207], v[48:63]
    ds_read_b64_tr_b16 v[36:37], v16 offset:43008
    ds_read_b64_tr_b16 v[38:39], v16 offset:43520
    s_waitcnt lgkmcnt(2)
    v_mfma_f32_32x32x16_bf16 v[48:63], v[32:35], v[208:211], v[48:63]
    ds_read_b64_tr_b16 v[32:33], v16 offset:45056
    ds_read_b64_tr_b16 v[34:35], v16 offset:45568
    s_waitcnt lgkmcnt(2)
    v_mfma_f32_32x32x16_bf16 v[48:63], v[36:39], v[212:215], v[48:63]
    ds_read_b64_tr_b16 v[36:37], v16 offset:47104
    ds_read_b64_tr_b16 v[38:39], v16 offset:47616
    s_waitcnt lgkmcnt(2)
    v_mfma_f32_32x32x16_bf16 v[48:63], v[32:35], v[216:219], v[48:63]
    ds_read_b64_tr_b16 v[32:33], v16 offset:49152
    ds_read_b64_tr_b16 v[34:35], v16 offset:49664
    s_waitcnt lgkmcnt(2)
    v_mfma_f32_32x32x16_bf16 v[48:63], v[36:39], v[220:223], v[48:63]
    ds_read_b64_tr_b16 v[36:37], v16 offset:51200
    ds_read_b64_tr_b16 v[38:39], v16 offset:51712
    s_waitcnt lgkmcnt(2)
    v_mfma_f32_32x32x16_bf16 v[48:63], v[32:35], v[224:227], v[48:63]
    ds_read_b64_tr_b16 v[32:33], v16 offset:53248
    ds_read_b64_tr_b16 v[34:35], v16 offset:53760
    s_waitcnt lgkmcnt(2)
    v_mfma_f32_32x32x16_bf16 v[48:63], v[36:39], v[228:231], v[48:63]
    ds_read_b64_tr_b16 v[36:37], v16 offset:55296
    ds_read_b64_tr_b16 v[38:39], v16 offset:55808
    s_waitcnt lgkmcnt(2)
    v_mfma_f32_32x32x16_bf16 v[48:63], v[32:35], v[232:235], v[48:63]
    ds_read_b64_tr_b16 v[32:33], v16 offset:57344
    ds_read_b64_tr_b16 v[34:35], v16 offset:57856
    s_waitcnt lgkmcnt(2)
    v_mfma_f32_32x32x16_bf16 v[48:63], v[36:39], v[236:239], v[48:63]
    ds_read_b64_tr_b16 v[36:37], v16 offset:59392
    ds_read_b64_tr_b16 v[38:39], v16 offset:59904
    s_waitcnt lgkmcnt(2)
    v_mfma_f32_32x32x16_bf16 v[48:63], v[32:35], v[240:243], v[48:63]
    ds_read_b64_tr_b16 v[32:33], v16 offset:61440
    ds_read_b64_tr_b16 v[34:35], v16 offset:61952
    s_waitcnt lgkmcnt(2)
    v_mfma_f32_32x32x16_bf16 v[48:63], v[36:39], v[244:247], v[48:63]
    ds_read_b64_tr_b16 v[36:37], v16 offset:63488
    ds_read_b64_tr_b16 v[38:39], v16 offset:64000
    s_waitcnt lgkmcnt(2)
    v_mfma_f32_32x32x16_bf16 v[48:63], v[32:35], v[248:251], v[48:63]
    s_waitcnt lgkmcnt(0)
    v_mfma_f32_32x32x16_bf16 v[48:63], v[36:39], v[252:255], v[48:63]
    s_and_b32 s55, s14, 1
    s_lshl_b32 s56, s19, 1
    s_add_u32 s55, s55, s56
    s_lshl_b32 s56, s55, 16
    s_lshl_b32 s57, s40, 7
    s_add_u32 s56, s56, s57
    s_lshr_b32 s57, s14, 1
    s_lshl_b32 s57, s57, 6
    s_add_u32 s56, s56, s57
    s_add_u32 s56, s56, 1024
    s_mov_b32 s24, s36
    s_mov_b32 s25, s37
    s_mov_b32 s26, 0x400000
    s_mov_b32 s27, 0x20000
    v_and_b32 v6, 31, v1
    v_lshlrev_b32 v6, 11, v6
    v_lshl_add_u32 v6, v13, 4, v6
    s_nop 7
    v_cvt_pk_bf16_f32 v32, v48, v49
    v_cvt_pk_bf16_f32 v33, v50, v51
    v_cvt_pk_bf16_f32 v34, v52, v53
    v_cvt_pk_bf16_f32 v35, v54, v55
    v_cvt_pk_bf16_f32 v36, v56, v57
    v_cvt_pk_bf16_f32 v37, v58, v59
    v_cvt_pk_bf16_f32 v38, v60, v61
    v_cvt_pk_bf16_f32 v39, v62, v63
    s_nop 1
    v_permlane32_swap_b32 v32, v34
    v_permlane32_swap_b32 v33, v35
    v_permlane32_swap_b32 v36, v38
    v_permlane32_swap_b32 v37, v39
    buffer_store_dwordx4 v[32:35], v6, s[24:27], s56 offen offset:0
    buffer_store_dwordx4 v[36:39], v6, s[24:27], s56 offen offset:32
    s_branch concat_heads__mha_block__sliding_local_dilated__prompt_kernel_t03
concat_heads__mha_block__sliding_local_dilated__prompt_kernel_t47:
    s_waitcnt vmcnt(0)
    v_mov_b32 v9, 0
    v_mov_b32 v10, s41
    s_mov_b64 exec, 1
    buffer_store_dword v10, v9, s[28:31], s48 offen offset:0 sc1
    s_mov_b64 exec, -1
    s_and_b32 s52, s14, 1
    s_bfe_u32 s53, s14, 0x10001
    s_lshl_b32 s55, s19, 1
    s_add_u32 s55, s55, s52
    s_lshl_b32 s56, s55, 15
    s_lshl_b32 s57, s53, 14
    s_add_u32 s56, s56, s57
    s_add_u32 s56, s56, 6291456
    s_lshl_b32 s58, s19, 8
    s_add_u32 s58, s58, 10518528
    v_lshrrev_b32 v3, 5, v1
    v_bfe_u32 v5, v1, 2, 2
    v_lshl_add_u32 v6, v3, 3, v5
    v_lshlrev_b32 v6, 7, v6
    v_bfe_u32 v7, v1, 4, 1
    v_lshl_add_u32 v6, v7, 5, v6
    v_and_b32 v7, 3, v1
    v_lshl_add_u32 v6, v7, 3, v6
    s_lshl_b32 s57, s53, 15
    v_add_u32 v6, s57, v6
    v_lshrrev_b32 v7, 1, v5
    v_lshl_add_u32 v16, v7, 6, v6
    v_xor_b32 v7, 1, v7
    v_lshl_add_u32 v17, v7, 6, v6
    ds_read_b64_tr_b16 v[24:25], v16 offset:0
    ds_read_b64_tr_b16 v[26:27], v16 offset:512
    ds_read_b64_tr_b16 v[28:29], v17 offset:0
    ds_read_b64_tr_b16 v[30:31], v17 offset:512
    s_lshl_b32 s57, s52, 7
    s_lshl_b32 s59, s53, 6
    s_add_u32 s57, s57, s59
    s_add_u32 s58, s58, s57
    s_mov_b64 exec, 0xffff
    v_lshlrev_b32 v9, 2, v1
    s_mov_b32 s49, 0
    buffer_load_dword v240, v9, s[28:31], s58 offen sc1
    s_sleep 2
    buffer_load_dword v241, v9, s[28:31], s58 offen sc1
    s_sleep 2
    buffer_load_dword v242, v9, s[28:31], s58 offen sc1
    s_sleep 2
    buffer_load_dword v243, v9, s[28:31], s58 offen sc1
concat_heads__mha_block__sliding_local_dilated__prompt_kernel_pA:
    s_waitcnt vmcnt(3)
    v_cmp_eq_u32 vcc, s41, v240
    s_nop 3
    s_cmp_eq_u64 vcc, exec
    s_cbranch_scc1 concat_heads__mha_block__sliding_local_dilated__prompt_kernel_pA_got
    buffer_load_dword v240, v9, s[28:31], s58 offen sc1
    s_waitcnt vmcnt(3)
    v_cmp_eq_u32 vcc, s41, v241
    s_nop 3
    s_cmp_eq_u64 vcc, exec
    s_cbranch_scc1 concat_heads__mha_block__sliding_local_dilated__prompt_kernel_pA_got
    buffer_load_dword v241, v9, s[28:31], s58 offen sc1
    s_waitcnt vmcnt(3)
    v_cmp_eq_u32 vcc, s41, v242
    s_nop 3
    s_cmp_eq_u64 vcc, exec
    s_cbranch_scc1 concat_heads__mha_block__sliding_local_dilated__prompt_kernel_pA_got
    buffer_load_dword v242, v9, s[28:31], s58 offen sc1
    s_waitcnt vmcnt(3)
    v_cmp_eq_u32 vcc, s41, v243
    s_nop 3
    s_cmp_eq_u64 vcc, exec
    s_cbranch_scc1 concat_heads__mha_block__sliding_local_dilated__prompt_kernel_pA_got
    buffer_load_dword v243, v9, s[28:31], s58 offen sc1
    s_add_u32 s49, s49, 1
    s_cmp_lt_u32 s49, 200000
    s_cbranch_scc1 concat_heads__mha_block__sliding_local_dilated__prompt_kernel_pA
concat_heads__mha_block__sliding_local_dilated__prompt_kernel_pA_got:
    s_mov_b64 exec, -1
    buffer_load_dwordx4 v[64:67], v4, s[28:31], s56 offen offset:0 sc1
    buffer_load_dwordx4 v[68:71], v4, s[28:31], s56 offen offset:1024 sc1
    buffer_load_dwordx4 v[72:75], v4, s[28:31], s56 offen offset:2048 sc1
    buffer_load_dwordx4 v[76:79], v4, s[28:31], s56 offen offset:3072 sc1
    s_add_u32 s56, s56, 4096
    buffer_load_dwordx4 v[80:83], v4, s[28:31], s56 offen offset:0 sc1
    buffer_load_dwordx4 v[84:87], v4, s[28:31], s56 offen offset:1024 sc1
    buffer_load_dwordx4 v[88:91], v4, s[28:31], s56 offen offset:2048 sc1
    buffer_load_dwordx4 v[92:95], v4, s[28:31], s56 offen offset:3072 sc1
    s_add_u32 s56, s56, 4096
    buffer_load_dwordx4 v[96:99], v4, s[28:31], s56 offen offset:0 sc1
    buffer_load_dwordx4 v[100:103], v4, s[28:31], s56 offen offset:1024 sc1
    buffer_load_dwordx4 v[104:107], v4, s[28:31], s56 offen offset:2048 sc1
    buffer_load_dwordx4 v[108:111], v4, s[28:31], s56 offen offset:3072 sc1
    s_add_u32 s56, s56, 4096
    buffer_load_dwordx4 v[112:115], v4, s[28:31], s56 offen offset:0 sc1
    buffer_load_dwordx4 v[116:119], v4, s[28:31], s56 offen offset:1024 sc1
    buffer_load_dwordx4 v[120:123], v4, s[28:31], s56 offen offset:2048 sc1
    buffer_load_dwordx4 v[124:127], v4, s[28:31], s56 offen offset:3072 sc1
    ds_read_b64_tr_b16 v[32:33], v16 offset:2048
    ds_read_b64_tr_b16 v[34:35], v16 offset:2560
    ds_read_b64_tr_b16 v[36:37], v17 offset:2048
    ds_read_b64_tr_b16 v[38:39], v17 offset:2560
    s_waitcnt vmcnt(15)
    s_waitcnt lgkmcnt(6)
    v_mfma_f32_32x32x16_bf16 v[192:207], v[24:27], v[64:67], 0
    s_waitcnt lgkmcnt(4)
    v_mfma_f32_32x32x16_bf16 v[208:223], v[28:31], v[64:67], 0
    ds_read_b64_tr_b16 v[24:25], v16 offset:4096
    ds_read_b64_tr_b16 v[26:27], v16 offset:4608
    ds_read_b64_tr_b16 v[28:29], v17 offset:4096
    ds_read_b64_tr_b16 v[30:31], v17 offset:4608
    s_waitcnt vmcnt(14)
    s_waitcnt lgkmcnt(6)
    v_mfma_f32_32x32x16_bf16 v[192:207], v[32:35], v[68:71], v[192:207]
    s_waitcnt lgkmcnt(4)
    v_mfma_f32_32x32x16_bf16 v[208:223], v[36:39], v[68:71], v[208:223]
    ds_read_b64_tr_b16 v[32:33], v16 offset:6144
    ds_read_b64_tr_b16 v[34:35], v16 offset:6656
    ds_read_b64_tr_b16 v[36:37], v17 offset:6144
    ds_read_b64_tr_b16 v[38:39], v17 offset:6656
    s_waitcnt vmcnt(13)
    s_waitcnt lgkmcnt(6)
    v_mfma_f32_32x32x16_bf16 v[192:207], v[24:27], v[72:75], v[192:207]
    s_waitcnt lgkmcnt(4)
    v_mfma_f32_32x32x16_bf16 v[208:223], v[28:31], v[72:75], v[208:223]
    ds_read_b64_tr_b16 v[24:25], v16 offset:8192
    ds_read_b64_tr_b16 v[26:27], v16 offset:8704
    ds_read_b64_tr_b16 v[28:29], v17 offset:8192
    ds_read_b64_tr_b16 v[30:31], v17 offset:8704
    s_waitcnt vmcnt(12)
    s_waitcnt lgkmcnt(6)
    v_mfma_f32_32x32x16_bf16 v[192:207], v[32:35], v[76:79], v[192:207]
    s_waitcnt lgkmcnt(4)
    v_mfma_f32_32x32x16_bf16 v[208:223], v[36:39], v[76:79], v[208:223]
    ds_read_b64_tr_b16 v[32:33], v16 offset:10240
    ds_read_b64_tr_b16 v[34:35], v16 offset:10752
    ds_read_b64_tr_b16 v[36:37], v17 offset:10240
    ds_read_b64_tr_b16 v[38:39], v17 offset:10752
    s_waitcnt vmcnt(11)
    s_waitcnt lgkmcnt(6)
    v_mfma_f32_32x32x16_bf16 v[192:207], v[24:27], v[80:83], v[192:207]
    s_waitcnt lgkmcnt(4)
    v_mfma_f32_32x32x16_bf16 v[208:223], v[28:31], v[80:83], v[208:223]
    ds_read_b64_tr_b16 v[24:25], v16 offset:12288
    ds_read_b64_tr_b16 v[26:27], v16 offset:12800
    ds_read_b64_tr_b16 v[28:29], v17 offset:12288
    ds_read_b64_tr_b16 v[30:31], v17 offset:12800
    s_waitcnt vmcnt(10)
    s_waitcnt lgkmcnt(6)
    v_mfma_f32_32x32x16_bf16 v[192:207], v[32:35], v[84:87], v[192:207]
    s_waitcnt lgkmcnt(4)
    v_mfma_f32_32x32x16_bf16 v[208:223], v[36:39], v[84:87], v[208:223]
    ds_read_b64_tr_b16 v[32:33], v16 offset:14336
    ds_read_b64_tr_b16 v[34:35], v16 offset:14848
    ds_read_b64_tr_b16 v[36:37], v17 offset:14336
    ds_read_b64_tr_b16 v[38:39], v17 offset:14848
    s_waitcnt vmcnt(9)
    s_waitcnt lgkmcnt(6)
    v_mfma_f32_32x32x16_bf16 v[192:207], v[24:27], v[88:91], v[192:207]
    s_waitcnt lgkmcnt(4)
    v_mfma_f32_32x32x16_bf16 v[208:223], v[28:31], v[88:91], v[208:223]
    ds_read_b64_tr_b16 v[24:25], v16 offset:16384
    ds_read_b64_tr_b16 v[26:27], v16 offset:16896
    ds_read_b64_tr_b16 v[28:29], v17 offset:16384
    ds_read_b64_tr_b16 v[30:31], v17 offset:16896
    s_waitcnt vmcnt(8)
    s_waitcnt lgkmcnt(6)
    v_mfma_f32_32x32x16_bf16 v[192:207], v[32:35], v[92:95], v[192:207]
    s_waitcnt lgkmcnt(4)
    v_mfma_f32_32x32x16_bf16 v[208:223], v[36:39], v[92:95], v[208:223]
    ds_read_b64_tr_b16 v[32:33], v16 offset:18432
    ds_read_b64_tr_b16 v[34:35], v16 offset:18944
    ds_read_b64_tr_b16 v[36:37], v17 offset:18432
    ds_read_b64_tr_b16 v[38:39], v17 offset:18944
    s_waitcnt vmcnt(7)
    s_waitcnt lgkmcnt(6)
    v_mfma_f32_32x32x16_bf16 v[192:207], v[24:27], v[96:99], v[192:207]
    s_waitcnt lgkmcnt(4)
    v_mfma_f32_32x32x16_bf16 v[208:223], v[28:31], v[96:99], v[208:223]
    ds_read_b64_tr_b16 v[24:25], v16 offset:20480
    ds_read_b64_tr_b16 v[26:27], v16 offset:20992
    ds_read_b64_tr_b16 v[28:29], v17 offset:20480
    ds_read_b64_tr_b16 v[30:31], v17 offset:20992
    s_waitcnt vmcnt(6)
    s_waitcnt lgkmcnt(6)
    v_mfma_f32_32x32x16_bf16 v[192:207], v[32:35], v[100:103], v[192:207]
    s_waitcnt lgkmcnt(4)
    v_mfma_f32_32x32x16_bf16 v[208:223], v[36:39], v[100:103], v[208:223]
    ds_read_b64_tr_b16 v[32:33], v16 offset:22528
    ds_read_b64_tr_b16 v[34:35], v16 offset:23040
    ds_read_b64_tr_b16 v[36:37], v17 offset:22528
    ds_read_b64_tr_b16 v[38:39], v17 offset:23040
    s_waitcnt vmcnt(5)
    s_waitcnt lgkmcnt(6)
    v_mfma_f32_32x32x16_bf16 v[192:207], v[24:27], v[104:107], v[192:207]
    s_waitcnt lgkmcnt(4)
    v_mfma_f32_32x32x16_bf16 v[208:223], v[28:31], v[104:107], v[208:223]
    ds_read_b64_tr_b16 v[24:25], v16 offset:24576
    ds_read_b64_tr_b16 v[26:27], v16 offset:25088
    ds_read_b64_tr_b16 v[28:29], v17 offset:24576
    ds_read_b64_tr_b16 v[30:31], v17 offset:25088
    s_waitcnt vmcnt(4)
    s_waitcnt lgkmcnt(6)
    v_mfma_f32_32x32x16_bf16 v[192:207], v[32:35], v[108:111], v[192:207]
    s_waitcnt lgkmcnt(4)
    v_mfma_f32_32x32x16_bf16 v[208:223], v[36:39], v[108:111], v[208:223]
    ds_read_b64_tr_b16 v[32:33], v16 offset:26624
    ds_read_b64_tr_b16 v[34:35], v16 offset:27136
    ds_read_b64_tr_b16 v[36:37], v17 offset:26624
    ds_read_b64_tr_b16 v[38:39], v17 offset:27136
    s_waitcnt vmcnt(3)
    s_waitcnt lgkmcnt(6)
    v_mfma_f32_32x32x16_bf16 v[192:207], v[24:27], v[112:115], v[192:207]
    s_waitcnt lgkmcnt(4)
    v_mfma_f32_32x32x16_bf16 v[208:223], v[28:31], v[112:115], v[208:223]
    ds_read_b64_tr_b16 v[24:25], v16 offset:28672
    ds_read_b64_tr_b16 v[26:27], v16 offset:29184
    ds_read_b64_tr_b16 v[28:29], v17 offset:28672
    ds_read_b64_tr_b16 v[30:31], v17 offset:29184
    s_waitcnt vmcnt(2)
    s_waitcnt lgkmcnt(6)
    v_mfma_f32_32x32x16_bf16 v[192:207], v[32:35], v[116:119], v[192:207]
    s_waitcnt lgkmcnt(4)
    v_mfma_f32_32x32x16_bf16 v[208:223], v[36:39], v[116:119], v[208:223]
    ds_read_b64_tr_b16 v[32:33], v16 offset:30720
    ds_read_b64_tr_b16 v[34:35], v16 offset:31232
    ds_read_b64_tr_b16 v[36:37], v17 offset:30720
    ds_read_b64_tr_b16 v[38:39], v17 offset:31232
    s_waitcnt vmcnt(1)
    s_waitcnt lgkmcnt(6)
    v_mfma_f32_32x32x16_bf16 v[192:207], v[24:27], v[120:123], v[192:207]
    s_waitcnt lgkmcnt(4)
    v_mfma_f32_32x32x16_bf16 v[208:223], v[28:31], v[120:123], v[208:223]
    s_waitcnt vmcnt(0)
    s_waitcnt lgkmcnt(2)
    v_mfma_f32_32x32x16_bf16 v[192:207], v[32:35], v[124:127], v[192:207]
    s_waitcnt lgkmcnt(0)
    v_mfma_f32_32x32x16_bf16 v[208:223], v[36:39], v[124:127], v[208:223]
    s_nop 15
    s_cmp_eq_u32 s53, 0
    s_cbranch_scc1 concat_heads__mha_block__sliding_local_dilated__prompt_kernel_r0
    v_mov_b32 v32, v192
    v_mov_b32 v192, v208
    v_mov_b32 v33, v193
    v_mov_b32 v193, v209
    v_mov_b32 v34, v194
    v_mov_b32 v194, v210
    v_mov_b32 v35, v195
    v_mov_b32 v195, v211
    v_mov_b32 v36, v196
    v_mov_b32 v196, v212
    v_mov_b32 v37, v197
    v_mov_b32 v197, v213
    v_mov_b32 v38, v198
    v_mov_b32 v198, v214
    v_mov_b32 v39, v199
    v_mov_b32 v199, v215
    v_mov_b32 v40, v200
    v_mov_b32 v200, v216
    v_mov_b32 v41, v201
    v_mov_b32 v201, v217
    v_mov_b32 v42, v202
    v_mov_b32 v202, v218
    v_mov_b32 v43, v203
    v_mov_b32 v203, v219
    v_mov_b32 v44, v204
    v_mov_b32 v204, v220
    v_mov_b32 v45, v205
    v_mov_b32 v205, v221
    v_mov_b32 v46, v206
    v_mov_b32 v206, v222
    v_mov_b32 v47, v207
    v_mov_b32 v207, v223
    s_branch concat_heads__mha_block__sliding_local_dilated__prompt_kernel_r1
concat_heads__mha_block__sliding_local_dilated__prompt_kernel_r0:
    v_mov_b32 v32, v208
    v_mov_b32 v33, v209
    v_mov_b32 v34, v210
    v_mov_b32 v35, v211
    v_mov_b32 v36, v212
    v_mov_b32 v37, v213
    v_mov_b32 v38, v214
    v_mov_b32 v39, v215
    v_mov_b32 v40, v216
    v_mov_b32 v41, v217
    v_mov_b32 v42, v218
    v_mov_b32 v43, v219
    v_mov_b32 v44, v220
    v_mov_b32 v45, v221
    v_mov_b32 v46, v222
    v_mov_b32 v47, v223
concat_heads__mha_block__sliding_local_dilated__prompt_kernel_r1:
    s_and_b32 s57, s14, 3
    s_lshl_b32 s57, s57, 12
    s_add_u32 s57, s57, 133120
    v_add_u32 v9, s57, v4
    ds_write_b128 v9, v[32:35] offset:0
    ds_write_b128 v9, v[36:39] offset:1024
    ds_write_b128 v9, v[40:43] offset:2048
    ds_write_b128 v9, v[44:47] offset:3072
    s_and_b32 s57, s14, 3
    s_xor_b32 s57, s57, 2
    s_lshl_b32 s57, s57, 12
    s_add_u32 s57, s57, 133120
    v_add_u32 v9, s57, v4
    s_waitcnt lgkmcnt(0)
    s_barrier
    ds_read_b128 v[32:35], v9 offset:0
    ds_read_b128 v[36:39], v9 offset:1024
    ds_read_b128 v[40:43], v9 offset:2048
    ds_read_b128 v[44:47], v9 offset:3072
    s_lshl_b32 s56, s55, 16
    s_lshl_b32 s57, s40, 7
    s_add_u32 s56, s56, s57
    s_lshl_b32 s57, s53, 6
    s_add_u32 s56, s56, s57
    s_mov_b32 s20, s36
    s_mov_b32 s21, s37
    s_mov_b32 s22, 0x400000
    s_mov_b32 s23, 0x20000
    v_and_b32 v2, 31, v1
    v_lshlrev_b32 v5, 11, v2
    v_lshl_add_u32 v5, v3, 4, v5
    s_waitcnt lgkmcnt(0)
    v_add_f32 v192, v192, v32
    v_add_f32 v193, v193, v33
    v_add_f32 v194, v194, v34
    v_add_f32 v195, v195, v35
    v_add_f32 v196, v196, v36
    v_add_f32 v197, v197, v37
    v_add_f32 v198, v198, v38
    v_add_f32 v199, v199, v39
    v_add_f32 v200, v200, v40
    v_add_f32 v201, v201, v41
    v_add_f32 v202, v202, v42
    v_add_f32 v203, v203, v43
    v_add_f32 v204, v204, v44
    v_add_f32 v205, v205, v45
    v_add_f32 v206, v206, v46
    v_add_f32 v207, v207, v47
    v_cvt_pk_bf16_f32 v48, v192, v193
    v_cvt_pk_bf16_f32 v49, v194, v195
    v_cvt_pk_bf16_f32 v50, v196, v197
    v_cvt_pk_bf16_f32 v51, v198, v199
    v_cvt_pk_bf16_f32 v52, v200, v201
    v_cvt_pk_bf16_f32 v53, v202, v203
    v_cvt_pk_bf16_f32 v54, v204, v205
    v_cvt_pk_bf16_f32 v55, v206, v207
    s_nop 1
    v_permlane32_swap_b32 v48, v50
    v_permlane32_swap_b32 v49, v51
    v_permlane32_swap_b32 v52, v54
    v_permlane32_swap_b32 v53, v55
    buffer_store_dwordx4 v[48:51], v5, s[20:23], s56 offen offset:0 nt
    buffer_store_dwordx4 v[52:55], v5, s[20:23], s56 offen offset:32 nt
concat_heads__mha_block__sliding_local_dilated__prompt_kernel_t03:
concat_heads__mha_block__sliding_local_dilated__prompt_kernel_end:
    s_endpgm
concat_heads__mha_block__sliding_local_dilated__prompt_kernel_sync:
    s_waitcnt vmcnt(0)
    s_barrier
    s_lshr_b32 s56, s2, 3
    s_lshl_b32 s56, s56, 3
    s_add_u32 s56, s56, s14
    s_lshl_b32 s56, s56, 11
    s_mov_b32 s20, s32
    s_mov_b32 s21, s33
    s_mov_b32 s22, 0x80000
    s_mov_b32 s23, 0x20000
    s_mov_b32 s24, s34
    s_mov_b32 s25, s35
    s_mov_b32 s26, 0x80000
    s_mov_b32 s27, 0x20000
    buffer_load_dwordx4 v[244:247], v4, s[24:27], s56 offen
    buffer_load_dwordx4 v[244:247], v4, s[24:27], s56 offen offset:1024
    buffer_load_dwordx4 v[244:247], v4, s[20:23], s56 offen
    buffer_load_dwordx4 v[244:247], v4, s[20:23], s56 offen offset:1024
    s_cmp_ge_u32 s14, 4
    s_cbranch_scc1 concat_heads__mha_block__sliding_local_dilated__prompt_kernel_nosync
    s_lshl_b32 s48, s15, 8
    s_lshl_b32 s56, s16, 2
    s_add_u32 s56, s56, s14
    s_lshl_b32 s56, s56, 2
    s_add_u32 s48, s48, s56
    s_add_u32 s48, s48, 10502144
    v_mov_b32 v9, 0
    v_mov_b32 v10, s41
    s_mov_b64 exec, 1
    buffer_store_dword v10, v9, s[28:31], s48 offen offset:0 sc1
    buffer_store_dword v10, v9, s[28:31], s48 offen offset:128 sc1
    s_mov_b64 exec, -1
    s_branch concat_heads__mha_block__sliding_local_dilated__prompt_kernel_nosync
concat_heads__mha_block__sliding_local_dilated__prompt_kernel_fallback:
    s_lshl_b32 s57, s17, 17
    s_add_u32 s57, s57, 2097152
    v_mov_b32 v10, 0xff800000
    s_mov_b32 s49, 0
    s_mov_b32 s58, s57
concat_heads__mha_block__sliding_local_dilated__prompt_kernel_fb1:
    buffer_load_dwordx4 v[84:87], v4, s[28:31], s58 offen sc1
    s_add_u32 s58, s58, 2048
    s_waitcnt vmcnt(0)
    v_mfma_f32_32x32x16_bf16 v[32:47], v[84:87], v[80:83], 0
    s_nop 15
    s_nop 3
    v_max3_f32 v10, v10, v32, v33
    v_max3_f32 v10, v10, v34, v35
    v_max3_f32 v10, v10, v36, v37
    v_max3_f32 v10, v10, v38, v39
    v_max3_f32 v10, v10, v40, v41
    v_max3_f32 v10, v10, v42, v43
    v_max3_f32 v10, v10, v44, v45
    v_max3_f32 v10, v10, v46, v47
    s_add_u32 s49, s49, 1
    s_cmp_lt_u32 s49, 64
    s_cbranch_scc1 concat_heads__mha_block__sliding_local_dilated__prompt_kernel_fb1
    v_mov_b32 v11, v10
    s_nop 1
    v_permlane32_swap_b32 v10, v11
    s_nop 1
    v_max_f32 v10, v10, v11
    v_sub_f32 v48, 0, v10
    v_sub_f32 v49, 0, v10
    v_sub_f32 v50, 0, v10
    v_sub_f32 v51, 0, v10
    v_sub_f32 v52, 0, v10
    v_sub_f32 v53, 0, v10
    v_sub_f32 v54, 0, v10
    v_sub_f32 v55, 0, v10
    v_sub_f32 v56, 0, v10
    v_sub_f32 v57, 0, v10
    v_sub_f32 v58, 0, v10
    v_sub_f32 v59, 0, v10
    v_sub_f32 v60, 0, v10
    v_sub_f32 v61, 0, v10
    v_sub_f32 v62, 0, v10
    v_sub_f32 v63, 0, v10
    v_mov_b32 v112, 0
    v_mov_b32 v113, 0
    v_mov_b32 v114, 0
    v_mov_b32 v115, 0
    v_mov_b32 v116, 0
    v_mov_b32 v117, 0
    v_mov_b32 v118, 0
    v_mov_b32 v119, 0
    v_mov_b32 v120, 0
    v_mov_b32 v121, 0
    v_mov_b32 v122, 0
    v_mov_b32 v123, 0
    v_mov_b32 v124, 0
    v_mov_b32 v125, 0
    v_mov_b32 v126, 0
    v_mov_b32 v127, 0
    v_mov_b32 v9, 0x3f803f80
    v_cndmask_b32_e64 v9, 0, v9, s[44:45]
    v_mov_b32 v92, v9
    v_mov_b32 v100, v9
    v_mov_b32 v93, v9
    v_mov_b32 v101, v9
    v_mov_b32 v94, v9
    v_mov_b32 v102, v9
    v_mov_b32 v95, v9
    v_mov_b32 v103, v9
    s_mov_b32 s49, 0
    s_mov_b32 s58, s57
concat_heads__mha_block__sliding_local_dilated__prompt_kernel_fb2:
    buffer_load_dwordx4 v[84:87], v4, s[28:31], s58 offen sc1
    s_mov_b64 exec, s[42:43]
    buffer_load_dwordx4 v[92:95], v5, s[28:31], s58 offen sc1
    buffer_load_dwordx4 v[100:103], v5, s[28:31], s58 offen offset:512 sc1
    s_mov_b64 exec, -1
    s_add_u32 s58, s58, 2048
    s_waitcnt vmcnt(0)
    v_mfma_f32_32x32x16_bf16 v[32:47], v[84:87], v[80:83], v[48:63]
    s_nop 15
    s_nop 3
    v_exp_f32 v32, v32
    v_exp_f32 v33, v33
    v_exp_f32 v34, v34
    v_exp_f32 v35, v35
    v_exp_f32 v36, v36
    v_exp_f32 v37, v37
    v_exp_f32 v38, v38
    v_exp_f32 v39, v39
    v_exp_f32 v40, v40
    v_exp_f32 v41, v41
    v_exp_f32 v42, v42
    v_exp_f32 v43, v43
    v_exp_f32 v44, v44
    v_exp_f32 v45, v45
    v_exp_f32 v46, v46
    v_exp_f32 v47, v47
    s_nop 3
    v_smfmac_f32_32x32x32_bf16 v[112:127], v[92:95], v[32:39], v108
    v_smfmac_f32_32x32x32_bf16 v[112:127], v[100:103], v[40:47], v108
    s_nop 15
    s_nop 3
    s_add_u32 s49, s49, 1
    s_cmp_lt_u32 s49, 64
    s_cbranch_scc1 concat_heads__mha_block__sliding_local_dilated__prompt_kernel_fb2
    s_nop 15
    s_nop 7
    v_cndmask_b32_e64 v16, v112, v116, s[46:47]
    v_cndmask_b32_e64 v20, v124, v120, s[46:47]
    v_cndmask_b32_e64 v17, v113, v117, s[46:47]
    v_cndmask_b32_e64 v21, v125, v121, s[46:47]
    v_cndmask_b32_e64 v18, v114, v118, s[46:47]
    v_cndmask_b32_e64 v22, v126, v122, s[46:47]
    v_cndmask_b32_e64 v19, v115, v119, s[46:47]
    v_cndmask_b32_e64 v23, v127, v123, s[46:47]
    v_mov_b32 v24, v116
    v_mov_b32 v25, v24
    s_nop 1
    v_permlane32_swap_b32 v24, v25
    s_nop 1
    s_branch concat_heads__mha_block__sliding_local_dilated__prompt_kernel_store
.section .rodata,"a"
.p2align 6
.amdhsa_kernel concat_heads__mha_block__sliding_local_dilated__prompt_kernel
  .amdhsa_next_free_vgpr 256
  .amdhsa_next_free_sgpr 100
  .amdhsa_accum_offset 256
  .amdhsa_group_segment_fixed_size 0
  .amdhsa_kernarg_size 72
  .amdhsa_user_sgpr_count 2
  .amdhsa_user_sgpr_kernarg_segment_ptr 1
  .amdhsa_system_sgpr_workgroup_id_x 1
.end_amdhsa_kernel
.text
```
